```python
import torch

def _softmax(x, axis=-1):
    return torch.softmax(x, dim=axis)
def _gelu(x):
    return torch.nn.functional.gelu(x, approximate="tanh")
def _silu(x):
    return torch.nn.functional.silu(x)
def _sigmoid(x):
    return torch.sigmoid(x)
def _layernorm(x, axis=-1, eps=1e-5):
    m = x.mean(dim=axis, keepdim=True)
    v = x.var(dim=axis, keepdim=True, unbiased=False)
    return (x - m) / torch.sqrt(v + eps)
def _scatter_add(tgt, idx, src, axis=0):
    return tgt.clone().index_add_(axis, idx, src)
def _segment_sum(src, seg, n):
    out = torch.zeros((n,) + src.shape[1:], dtype=src.dtype)
    return out.index_add_(0, seg, src)
def _pad(x, pw):
    flat = tuple(v for pair in reversed(pw) for v in pair)
    return torch.nn.functional.pad(x, flat)

kernel_name = 'standalone__mha_block_cached__near_ridge'

def setup_inputs():

    _w = (lambda a: (lambda t: t.to(torch.bfloat16) if t.is_floating_point() else t)(torch.as_tensor(a)))
    B, Sq, D = 8, 192, 576
    H, Sk, Dh = 32, 512, 128
    return {
        "x": _w((lambda *s: torch.randn(*s, dtype=torch.bfloat16) * 0.8)(B, Sq, D)),
        "k_cache": _w((lambda *s: torch.randn(*s, dtype=torch.bfloat16) * 0.8)(B, H, Sk, Dh)),
        "v_cache": _w((lambda *s: torch.randn(*s, dtype=torch.bfloat16) * 0.05)(B, H, Sk, Dh)),
        "wq": _w((lambda *s: torch.randn(*s, dtype=torch.bfloat16) * 0.8)(D, H * Dh) * (D ** -0.5)),
        "wo": _w((lambda *s: torch.randn(*s, dtype=torch.bfloat16) * 0.05)(H * Dh, D) * ((H * Dh) ** -0.5)),
    }

def reference(x, k_cache, v_cache, wq, wo):
    B, Sq, D = x.shape
    H, Dh = 32, 128
    q = (lambda x, *d: x.permute(*d))((x @ wq).reshape(B, Sq, H, Dh), 0, 2, 1, 3)
    scores = torch.einsum("bhqd,bhkd->bhqk", q, k_cache) * (Dh ** -0.5)
    p = _softmax(scores, axis=-1)
    o = torch.einsum("bhqk,bhkd->bhqd", p, v_cache)
    return (lambda x, *d: x.permute(*d))(o, 0, 2, 1, 3).reshape(B, Sq, H * Dh) @ wo
```

```asm
; @launch grid=(256,1,1) block=(512,1,1) lds=163840
.amdgcn_target "amdgcn-amd-amdhsa--gfx950"
.text
.globl standalone__mha_block_cached__near_ridge_kernel
.p2align 8
.type standalone__mha_block_cached__near_ridge_kernel,@function
standalone__mha_block_cached__near_ridge_kernel:
    s_cmp_ge_u32 s2, 256
    s_cbranch_scc1 L_endA
    s_load_dwordx8 s[4:11], s[0:1], 0
    s_load_dwordx8 s[12:19], s[0:1], 32
    v_lshrrev_b32 v2, 6, v0
    v_and_b32 v1, 63, v0
    v_readfirstlane_b32 s40, v2
    s_lshr_b32 s44, s2, 3
    s_and_b32 s41, s2, 1
    s_lshl_b32 s41, s41, 2
    s_and_b32 s44, s44, 3
    s_add_u32 s41, s41, s44
    s_and_b32 s42, s2, 6
    s_lshl_b32 s42, s42, 2
    s_lshr_b32 s45, s2, 5
    s_add_u32 s42, s42, s45
    s_lshl_b32 s43, s44, 1
    s_add_u32 s43, s43, s45
    s_cmp_ge_u32 s43, 9
    s_cselect_b32 s45, 9, 0
    s_sub_u32 s43, s43, s45
    s_and_b32 s46, s40, 1
    s_mov_b32 s48, 0
    s_cmp_ge_u32 s40, 4
    s_cbranch_scc1 L_compute
    s_cmp_ge_u32 s40, 2
    s_cbranch_scc1 L_hkv
    v_lshrrev_b32 v2, 3, v1
    s_mul_i32 s44, s46, 96
    v_add_u32 v2, s44, v2
    v_mul_u32_u24 v2, 1152, v2
    v_lshrrev_b32 v4, 4, v1
    v_and_b32 v3, 7, v1
    v_xor_b32 v3, v3, v4
    v_lshl_add_u32 v8, v3, 4, v2
    v_xor_b32 v3, 4, v3
    v_lshl_add_u32 v9, v3, 4, v2
    v_add_u32 v9, 8192, v9
    v_add_u32 v10, 16384, v8
    v_add_u32 v11, 16384, v9
    s_lshl_b32 s44, s46, 4
    v_add_u32 v2, s44, v4
    v_lshlrev_b32 v2, 13, v2
    v_and_b32 v3, 1, v4
    v_lshrrev_b32 v5, 5, v1
    v_lshl_or_b32 v3, v5, 2, v3
    v_and_b32 v5, 15, v1
    v_xor_b32 v3, v3, v5
    v_lshl_add_u32 v12, v3, 4, v2
    v_add_u32 v13, 31744, v12
    v_xor_b32 v14, 128, v12
    v_add_u32 v14, 63488, v14
    v_add_u32 v15, 31744, v14
    s_lshl_b32 s44, s46, 12
    s_add_u32 s49, s44, 106496
    s_add_u32 s51, s44, 131072
    s_mul_i32 s50, s46, 12288
    s_add_u32 s52, s50, 73728
    s_mov_b32 s47, 0
    s_mul_i32 s44, s41, 221184
    s_lshl_b32 s45, s42, 8
    s_waitcnt lgkmcnt(0)
    s_add_u32 s20, s4, s44
    s_addc_u32 s21, s5, 0
    s_mov_b32 s22, 221184
    s_mov_b32 s23, 0x00020000
    s_add_u32 s32, s10, s45
    s_addc_u32 s33, s11, 0
    s_sub_u32 s34, 4718592, s45
    s_mov_b32 s35, 0x00020000
L_xw:
    s_mov_b32 m0, s49
    s_lshl_b32 s44, s43, 19
    buffer_load_dwordx4 v12, s[32:35], s44 offen offset:0 lds
    buffer_load_dwordx4 v13, s[32:35], s44 offen offset:1024 lds
    buffer_load_dwordx4 v14, s[32:35], s44 offen offset:2048 lds
    buffer_load_dwordx4 v15, s[32:35], s44 offen offset:3072 lds
    s_add_u32 s49, s49, 8192
    s_cmp_eq_u32 s49, s51
    s_cselect_b32 s44, 57344, 0
    s_sub_u32 s49, s49, s44
    s_lshl_b32 s45, s43, 7
    s_add_u32 m0, s50, 0
    s_nop 0
    buffer_load_dwordx4 v8, s[20:23], s45 offen offset:0 lds
    buffer_load_dwordx4 v9, s[20:23], s45 offen offset:1024 lds
    buffer_load_dwordx4 v10, s[20:23], s45 offen offset:2048 lds
    buffer_load_dwordx4 v11, s[20:23], s45 offen offset:3072 lds
    s_add_u32 m0, s50, 4096
    s_add_u32 s45, s45, 36864
    buffer_load_dwordx4 v8, s[20:23], s45 offen offset:0 lds
    buffer_load_dwordx4 v9, s[20:23], s45 offen offset:1024 lds
    buffer_load_dwordx4 v10, s[20:23], s45 offen offset:2048 lds
    buffer_load_dwordx4 v11, s[20:23], s45 offen offset:3072 lds
    s_add_u32 m0, s50, 8192
    s_add_u32 s45, s45, 36864
    buffer_load_dwordx4 v8, s[20:23], s45 offen offset:0 lds
    buffer_load_dwordx4 v9, s[20:23], s45 offen offset:1024 lds
    buffer_load_dwordx4 v10, s[20:23], s45 offen offset:2048 lds
    buffer_load_dwordx4 v11, s[20:23], s45 offen offset:3072 lds
    s_mov_b32 m0, s49
    s_lshl_b32 s44, s43, 19
    s_add_u32 s44, s44, 262144
    buffer_load_dwordx4 v12, s[32:35], s44 offen offset:0 lds
    buffer_load_dwordx4 v13, s[32:35], s44 offen offset:1024 lds
    buffer_load_dwordx4 v14, s[32:35], s44 offen offset:2048 lds
    buffer_load_dwordx4 v15, s[32:35], s44 offen offset:3072 lds
    s_add_u32 s49, s49, 8192
    s_cmp_eq_u32 s49, s51
    s_cselect_b32 s44, 57344, 0
    s_sub_u32 s49, s49, s44
    s_add_u32 s50, s50, 24576
    s_cmp_eq_u32 s50, s52
    s_cselect_b32 s44, 73728, 0
    s_sub_u32 s50, s50, s44
    s_add_u32 s43, s43, 1
    s_cmp_eq_u32 s43, 9
    s_cselect_b32 s43, 0, s43
    s_add_u32 s47, s47, 1
    s_cmp_eq_u32 s47, 1
    s_cbranch_scc1 L_xw
    s_waitcnt vmcnt(20)
    s_barrier
    s_cmp_lt_u32 s47, 9
    s_cbranch_scc1 L_xw
    s_waitcnt vmcnt(0)
    s_barrier
    s_mov_b32 s55, 0
    s_branch L_h9
L_hkv:
    v_lshrrev_b32 v4, 4, v1
    v_and_b32 v5, 15, v1
    s_lshl_b32 s50, s46, 13
    v_lshl_add_u32 v3, v4, 8, s50
    v_xor_b32 v2, v4, v5
    v_lshl_add_u32 v8, v2, 4, v3
    v_xor_b32 v9, 64, v8
    v_xor_b32 v10, 4224, v8
    v_xor_b32 v11, 4288, v8
    v_lshlrev_b32 v2, 1, v4
    v_xor_b32 v2, v2, v5
    v_lshl_add_u32 v12, v2, 4, v3
    v_xor_b32 v13, 128, v12
    v_xor_b32 v14, 4096, v12
    v_xor_b32 v15, 4224, v12
    v_mov_b32 v18, 0
    s_lshl_b32 s44, s41, 5
    s_add_u32 s44, s44, s42
    s_lshl_b32 s44, s44, 17
    s_waitcnt lgkmcnt(0)
    s_add_u32 s24, s6, s44
    s_addc_u32 s25, s7, 0
    s_mov_b32 s26, 131072
    s_mov_b32 s27, 0x00020000
    s_add_u32 s28, s8, s44
    s_addc_u32 s29, s9, 0
    s_mov_b32 s30, 131072
    s_mov_b32 s31, 0x00020000
    s_mov_b32 s32, s16
    s_mov_b32 s33, s17
    s_mov_b32 s34, 0x100
    s_mov_b32 s35, 0x00020000
    s_or_b32 s44, s2, s46
    s_cmp_lg_u32 s44, 0
    s_cbranch_scc1 L_kv0
    s_memrealtime s[54:55]
    s_waitcnt lgkmcnt(0)
    s_or_b32 s54, s54, 1
    v_mov_b32 v16, s54
    v_mov_b32 v17, s55
    s_mov_b64 exec, 1
    buffer_store_dwordx2 v[16:17], v18, s[32:35], 0 offen sc1
    s_mov_b64 exec, -1
L_kv0:
    s_mov_b32 s20, s12
    s_mov_b32 s21, s13
    s_mov_b32 s22, 0x480000
    s_mov_b32 s23, 0x00020000
    s_mov_b32 s36, s18
    s_mov_b32 s37, s19
    s_mov_b32 s38, 0x10000000
    s_mov_b32 s39, 0x00020000
    v_lshlrev_b32 v21, 4, v1
    s_movk_i32 s44, 7282
    s_movk_i32 s45, 1008
    v_mul_u32_u24 v3, s44, v1
    v_lshrrev_b32 v2, 16, v3
    v_mad_u32_u24 v22, v2, s45, v21
    v_add_u32 v2, 466048, v3
    v_lshrrev_b32 v2, 16, v2
    v_mad_u32_u24 v23, v2, s45, v21
    v_add_u32 v2, 932096, v3
    v_lshrrev_b32 v2, 16, v2
    v_mad_u32_u24 v24, v2, s45, v21
    v_add_u32 v2, 1398144, v3
    v_lshrrev_b32 v2, 16, v2
    v_mad_u32_u24 v25, v2, s45, v21
    v_add_u32 v2, 1864192, v3
    v_lshrrev_b32 v2, 16, v2
    v_mad_u32_u24 v26, v2, s45, v21
    v_add_u32 v2, 2330240, v3
    v_lshrrev_b32 v2, 16, v2
    v_mad_u32_u24 v27, v2, s45, v21
    v_add_u32 v2, 2796288, v3
    v_lshrrev_b32 v2, 16, v2
    v_mad_u32_u24 v28, v2, s45, v21
    v_add_u32 v2, 3262336, v3
    v_lshrrev_b32 v2, 16, v2
    v_mad_u32_u24 v29, v2, s45, v21
    v_add_u32 v2, 3728384, v3
    v_lshrrev_b32 v2, 16, v2
    v_mad_u32_u24 v30, v2, s45, v21
    s_lshl_b32 s77, s46, 14
    s_add_u32 s77, s77, 131072
    v_lshrrev_b32 v2, 2, v1
    v_mul_u32_u24 v2, 144, v2
    v_and_b32 v3, 3, v1
    v_lshl_add_u32 v2, v3, 3, v2
    v_add_u32 v19, s77, v2
    v_bfe_u32 v3, v1, 1, 1
    v_mul_u32_u24 v3, 4592, v3
    v_add_u32 v20, v19, v3
    s_and_b32 s75, s2, 3
    s_lshl_b32 s75, s75, 1
    s_add_u32 s75, s75, s46
    s_lshr_b32 s74, s2, 2
    s_mul_i32 s78, s74, 73728
    s_mul_i32 s44, s75, 144
    s_add_u32 s78, s78, s44
    s_mul_i32 s76, s75, 589824
    s_lshr_b32 s44, s74, 3
    s_mul_i32 s44, s44, 73728
    s_add_u32 s76, s76, s44
    s_and_b32 s44, s74, 7
    s_lshl_b32 s44, s44, 10
    s_add_u32 s76, s76, s44
    s_add_u32 s76, s76, 20971520
    v_lshl_add_u32 v240, v1, 4, s50
    v_add_u32 v241, 65536, v240
    s_mov_b32 s55, 1
    s_barrier
    s_add_u32 m0, s77, 0
    s_add_u32 s44, s78, 0
    buffer_load_dwordx4 v22, s[20:23], s44 offen offset:0 lds
    buffer_load_dwordx4 v23, s[20:23], s44 offen offset:1024 lds
    buffer_load_dwordx4 v24, s[20:23], s44 offen offset:2048 lds
    buffer_load_dwordx4 v25, s[20:23], s44 offen offset:3072 lds
    s_add_u32 m0, s77, 4096
    s_add_u32 s44, s78, 4096
    buffer_load_dwordx4 v26, s[20:23], s44 offen offset:0 lds
    buffer_load_dwordx4 v27, s[20:23], s44 offen offset:1024 lds
    buffer_load_dwordx4 v28, s[20:23], s44 offen offset:2048 lds
    buffer_load_dwordx4 v29, s[20:23], s44 offen offset:3072 lds
    s_add_u32 m0, s77, 8192
    s_add_u32 s44, s78, 8192
    buffer_load_dwordx4 v30, s[20:23], s44 offen offset:0 lds
    s_barrier
    buffer_load_dwordx2 v[16:17], v18, s[32:35], 0 offen sc1
    s_barrier
    s_waitcnt vmcnt(1)
    ds_read_b64_tr_b16 v[32:33], v19 offset:0
    ds_read_b64_tr_b16 v[34:35], v19 offset:2304
    ds_read_b64_tr_b16 v[36:37], v19 offset:32
    ds_read_b64_tr_b16 v[38:39], v19 offset:2336
    ds_read_b64_tr_b16 v[40:41], v19 offset:64
    ds_read_b64_tr_b16 v[42:43], v19 offset:2368
    ds_read_b64_tr_b16 v[44:45], v19 offset:96
    ds_read_b64_tr_b16 v[46:47], v19 offset:2400
    ds_read_b64_tr_b16 v[48:49], v19 offset:4608
    ds_read_b64_tr_b16 v[50:51], v19 offset:6912
    ds_read_b64_tr_b16 v[52:53], v19 offset:4640
    ds_read_b64_tr_b16 v[54:55], v19 offset:6944
    ds_read_b64_tr_b16 v[56:57], v19 offset:4672
    ds_read_b64_tr_b16 v[58:59], v19 offset:6976
    ds_read_b64_tr_b16 v[60:61], v19 offset:4704
    ds_read_b64_tr_b16 v[62:63], v19 offset:7008
    ds_read_b64_tr_b16 v[64:65], v20 offset:128
    ds_read_b64_tr_b16 v[66:67], v20 offset:2432
    s_add_u32 s44, s76, 0
    s_waitcnt lgkmcnt(15)
    buffer_store_dwordx4 v[32:35], v21, s[36:39], s44 offen sc1
    s_add_u32 s44, s76, 8192
    s_waitcnt lgkmcnt(14)
    buffer_store_dwordx4 v[36:39], v21, s[36:39], s44 offen sc1
    s_add_u32 s44, s76, 16384
    s_waitcnt lgkmcnt(12)
    buffer_store_dwordx4 v[40:43], v21, s[36:39], s44 offen sc1
    s_add_u32 s44, s76, 24576
    s_waitcnt lgkmcnt(10)
    buffer_store_dwordx4 v[44:47], v21, s[36:39], s44 offen sc1
    s_add_u32 s44, s76, 32768
    s_waitcnt lgkmcnt(8)
    buffer_store_dwordx4 v[48:51], v21, s[36:39], s44 offen sc1
    s_add_u32 s44, s76, 40960
    s_waitcnt lgkmcnt(6)
    buffer_store_dwordx4 v[52:55], v21, s[36:39], s44 offen sc1
    s_add_u32 s44, s76, 49152
    s_waitcnt lgkmcnt(4)
    buffer_store_dwordx4 v[56:59], v21, s[36:39], s44 offen sc1
    s_add_u32 s44, s76, 57344
    s_waitcnt lgkmcnt(2)
    buffer_store_dwordx4 v[60:63], v21, s[36:39], s44 offen sc1
    s_add_u32 s44, s76, 65536
    s_waitcnt lgkmcnt(0)
    buffer_store_dwordx4 v[64:67], v21, s[36:39], s44 offen sc1
    s_barrier
    s_mov_b32 s44, 0
    s_add_u32 m0, s50, 131072
    s_nop 0
    buffer_load_dwordx4 v8, s[24:27], s44 offen offset:0 nt lds
    buffer_load_dwordx4 v8, s[24:27], s44 offen offset:1024 nt lds
    buffer_load_dwordx4 v9, s[24:27], s44 offen offset:2048 nt lds
    buffer_load_dwordx4 v9, s[24:27], s44 offen offset:3072 nt lds
    s_add_u32 m0, s50, 135168
    s_nop 0
    buffer_load_dwordx4 v10, s[24:27], s44 offen offset:0 nt lds
    buffer_load_dwordx4 v10, s[24:27], s44 offen offset:1024 nt lds
    buffer_load_dwordx4 v11, s[24:27], s44 offen offset:2048 nt lds
    buffer_load_dwordx4 v11, s[24:27], s44 offen offset:3072 nt lds
    s_add_u32 m0, s50, 147456
    s_nop 0
    buffer_load_dwordx4 v12, s[28:31], s44 offen offset:0 nt lds
    buffer_load_dwordx4 v12, s[28:31], s44 offen offset:1024 nt lds
    buffer_load_dwordx4 v13, s[28:31], s44 offen offset:2048 nt lds
    buffer_load_dwordx4 v13, s[28:31], s44 offen offset:3072 nt lds
    s_add_u32 m0, s50, 151552
    s_nop 0
    buffer_load_dwordx4 v14, s[28:31], s44 offen offset:0 nt lds
    buffer_load_dwordx4 v14, s[28:31], s44 offen offset:1024 nt lds
    buffer_load_dwordx4 v15, s[28:31], s44 offen offset:2048 nt lds
    buffer_load_dwordx4 v15, s[28:31], s44 offen offset:3072 nt lds
    s_barrier
    s_waitcnt vmcnt(16)
    s_mov_b32 s47, 0
L_kv_non:
    v_cmp_eq_u32 vcc, 0, v16
    s_cbranch_vccz L_kv_non_d
    s_sleep 2
    buffer_load_dwordx2 v[16:17], v18, s[32:35], 0 offen sc1
    s_add_u32 s47, s47, 1
    s_waitcnt vmcnt(0)
    s_cmp_lt_u32 s47, 0x100000
    s_cbranch_scc1 L_kv_non
L_kv_non_d:
    s_barrier
    s_cmp_lg_u32 s46, 0
    s_cbranch_scc1 L_kv_nf
    s_and_b32 s44, s2, 3
    s_lshl_b32 s44, s44, 6
    s_add_u32 s44, s44, s74
    s_lshl_b32 s44, s44, 3
    s_add_u32 s44, s44, 17825792
    s_mov_b64 exec, 1
    buffer_store_dwordx2 v[16:17], v18, s[36:39], s44 offen sc1
    s_mov_b64 exec, -1
L_kv_nf:
    s_mov_b32 s44, 16384
    buffer_load_dwordx4 v[80:83], v8, s[24:27], s44 offen offset:0 nt
    buffer_load_dwordx4 v[84:87], v8, s[24:27], s44 offen offset:1024 nt
    buffer_load_dwordx4 v[88:91], v9, s[24:27], s44 offen offset:2048 nt
    buffer_load_dwordx4 v[92:95], v9, s[24:27], s44 offen offset:3072 nt
    buffer_load_dwordx4 v[96:99], v10, s[24:27], s44 offen offset:0 nt
    buffer_load_dwordx4 v[100:103], v10, s[24:27], s44 offen offset:1024 nt
    buffer_load_dwordx4 v[104:107], v11, s[24:27], s44 offen offset:2048 nt
    buffer_load_dwordx4 v[108:111], v11, s[24:27], s44 offen offset:3072 nt
    buffer_load_dwordx4 v[112:115], v12, s[28:31], s44 offen offset:0 nt
    buffer_load_dwordx4 v[116:119], v12, s[28:31], s44 offen offset:1024 nt
    buffer_load_dwordx4 v[120:123], v13, s[28:31], s44 offen offset:2048 nt
    buffer_load_dwordx4 v[124:127], v13, s[28:31], s44 offen offset:3072 nt
    buffer_load_dwordx4 v[128:131], v14, s[28:31], s44 offen offset:0 nt
    buffer_load_dwordx4 v[132:135], v14, s[28:31], s44 offen offset:1024 nt
    buffer_load_dwordx4 v[136:139], v15, s[28:31], s44 offen offset:2048 nt
    buffer_load_dwordx4 v[140:143], v15, s[28:31], s44 offen offset:3072 nt
    s_barrier
    s_barrier
    s_mov_b32 s44, 32768
    buffer_load_dwordx4 v[176:179], v8, s[24:27], s44 offen offset:0 nt
    buffer_load_dwordx4 v[180:183], v8, s[24:27], s44 offen offset:1024 nt
    buffer_load_dwordx4 v[184:187], v9, s[24:27], s44 offen offset:2048 nt
    buffer_load_dwordx4 v[188:191], v9, s[24:27], s44 offen offset:3072 nt
    buffer_load_dwordx4 v[192:195], v10, s[24:27], s44 offen offset:0 nt
    buffer_load_dwordx4 v[196:199], v10, s[24:27], s44 offen offset:1024 nt
    buffer_load_dwordx4 v[200:203], v11, s[24:27], s44 offen offset:2048 nt
    buffer_load_dwordx4 v[204:207], v11, s[24:27], s44 offen offset:3072 nt
    buffer_load_dwordx4 v[208:211], v12, s[28:31], s44 offen offset:0 nt
    buffer_load_dwordx4 v[212:215], v12, s[28:31], s44 offen offset:1024 nt
    buffer_load_dwordx4 v[216:219], v13, s[28:31], s44 offen offset:2048 nt
    buffer_load_dwordx4 v[220:223], v13, s[28:31], s44 offen offset:3072 nt
    buffer_load_dwordx4 v[224:227], v14, s[28:31], s44 offen offset:0 nt
    buffer_load_dwordx4 v[228:231], v14, s[28:31], s44 offen offset:1024 nt
    buffer_load_dwordx4 v[232:235], v15, s[28:31], s44 offen offset:2048 nt
    buffer_load_dwordx4 v[236:239], v15, s[28:31], s44 offen offset:3072 nt
    s_barrier
    s_mov_b32 s44, 49152
    buffer_load_dwordx4 v[16:19], v8, s[24:27], s44 offen offset:0 nt
    buffer_load_dwordx4 v[20:23], v8, s[24:27], s44 offen offset:1024 nt
    buffer_load_dwordx4 v[24:27], v9, s[24:27], s44 offen offset:2048 nt
    buffer_load_dwordx4 v[28:31], v9, s[24:27], s44 offen offset:3072 nt
    buffer_load_dwordx4 v[32:35], v10, s[24:27], s44 offen offset:0 nt
    buffer_load_dwordx4 v[36:39], v10, s[24:27], s44 offen offset:1024 nt
    buffer_load_dwordx4 v[40:43], v11, s[24:27], s44 offen offset:2048 nt
    buffer_load_dwordx4 v[44:47], v11, s[24:27], s44 offen offset:3072 nt
    buffer_load_dwordx4 v[48:51], v12, s[28:31], s44 offen offset:0 nt
    buffer_load_dwordx4 v[52:55], v12, s[28:31], s44 offen offset:1024 nt
    buffer_load_dwordx4 v[56:59], v13, s[28:31], s44 offen offset:2048 nt
    buffer_load_dwordx4 v[60:63], v13, s[28:31], s44 offen offset:3072 nt
    buffer_load_dwordx4 v[64:67], v14, s[28:31], s44 offen offset:0 nt
    buffer_load_dwordx4 v[68:71], v14, s[28:31], s44 offen offset:1024 nt
    buffer_load_dwordx4 v[72:75], v15, s[28:31], s44 offen offset:2048 nt
    buffer_load_dwordx4 v[76:79], v15, s[28:31], s44 offen offset:3072 nt
    s_waitcnt vmcnt(56)
L_h9:
    s_barrier
    s_and_b32 s74, s2, 6
    s_lshl_b32 s74, s74, 2
    s_bfe_u32 s44, s2, 0x30003
    s_add_u32 s74, s74, s44
    s_lshr_b32 s75, s2, 6
    s_and_b32 s44, s2, 1
    s_lshl_b32 s44, s44, 2
    s_add_u32 s75, s75, s44
    s_and_b32 s44, s74, 3
    s_mul_i32 s44, s44, 0
    s_mul_i32 s67, s75, 0
    s_add_u32 s67, s67, s44
    s_and_b32 s67, s67, 0
    s_and_b32 s45, s74, 0
    s_lshl_b32 s45, s45, 2
    s_xor_b32 s66, s45, s40
    s_mul_i32 s77, s75, 589824
    s_add_u32 s77, s77, 20971520
    s_mul_i32 s44, s67, 73728
    s_add_u32 s77, s77, s44
    s_lshl_b32 s44, s66, 10
    s_add_u32 s76, s77, s44
    s_lshl_b32 s44, s40, 11
    s_add_u32 s77, s77, s44
    s_mul_i32 s78, s74, 393216
    s_lshl_b32 s44, s66, 11
    s_add_u32 s78, s78, s44
    s_lshl_b32 s44, s67, 14
    s_add_u32 s78, s78, s44
    s_add_u32 s79, s78, 131072
    s_add_u32 s80, s78, 262144
    v_mbcnt_lo_u32_b32 v152, -1, 0
    v_mbcnt_hi_u32_b32 v152, -1, v152
    v_lshlrev_b32 v252, 4, v152
    s_lshl_b32 s44, s66, 10
    v_add_u32 v253, s44, v252
    v_add_u32 v254, 65536, v253
    v_add_u32 v255, 131072, v253
    s_lshl_b32 s50, s40, 12
    v_lshrrev_b32 v154, 4, v152
    v_and_b32 v155, 15, v152
    v_lshl_add_u32 v153, v154, 8, s50
    v_xor_b32 v148, v154, v155
    v_lshl_add_u32 v148, v148, 4, v153
    s_lshl_b32 s44, s46, 7
    v_xor_b32 v148, s44, v148
    v_xor_b32 v149, 64, v148
    v_lshlrev_b32 v150, 1, v154
    v_xor_b32 v150, v150, v155
    v_lshl_add_u32 v150, v150, 4, v153
    v_xor_b32 v151, 128, v150
    v_and_b32 v146, 31, v152
    v_lshlrev_b32 v146, 8, v146
    s_lshl_b32 s44, s41, 5
    s_add_u32 s44, s44, s42
    s_lshl_b32 s44, s44, 17
    s_add_u32 s24, s6, s44
    s_addc_u32 s25, s7, 0
    s_mov_b32 s26, 131072
    s_mov_b32 s27, 0x00020000
    s_add_u32 s28, s8, s44
    s_addc_u32 s29, s9, 0
    s_mov_b32 s30, 131072
    s_mov_b32 s31, 0x00020000
    s_mov_b32 s32, s16
    s_mov_b32 s33, s17
    s_mov_b32 s34, 0x100
    s_mov_b32 s35, 0x00020000
    s_mov_b32 s36, s18
    s_mov_b32 s37, s19
    s_mov_b32 s38, 0x10000000
    s_mov_b32 s39, 0x00020000
    v_mov_b32 v144, 0
    v_mov_b32 v145, 0
    s_cmp_ge_u32 s40, 2
    s_cbranch_scc1 L_h_nochk
    v_mov_b32 v152, 0
    buffer_load_dwordx2 v[144:145], v152, s[32:35], 0 offen sc1
    v_lshrrev_b32 v153, 1, v252
    s_lshr_b32 s44, s75, 1
    s_lshl_b32 s44, s44, 9
    s_add_u32 s44, s44, 17825792
    buffer_load_dwordx2 v[154:155], v153, s[36:39], s44 offen sc1
    s_waitcnt vmcnt(0)
    s_mov_b32 s47, 0
L_h_non:
    v_cmp_eq_u32 vcc, 0, v144
    s_cbranch_vccz L_h_non_d
    s_sleep 2
    buffer_load_dwordx2 v[144:145], v152, s[32:35], 0 offen sc1
    s_add_u32 s47, s47, 1
    s_waitcnt vmcnt(0)
    s_cmp_lt_u32 s47, 0x100000
    s_cbranch_scc1 L_h_non
L_h_non_d:
    s_mov_b32 s47, 0
L_h_chk:
    v_cmp_ne_u64 vcc, v[154:155], v[144:145]
    s_cbranch_vccz L_h_chkd
    s_sleep 2
    buffer_load_dwordx2 v[154:155], v153, s[36:39], s44 offen sc1
    s_add_u32 s47, s47, 1
    s_waitcnt vmcnt(0)
    s_cmp_lt_u32 s47, 0x100000
    s_cbranch_scc1 L_h_chk
L_h_chkd:
L_h_nochk:
    s_cmp_eq_u32 s55, 0
    s_cbranch_scc1 L_nd_1
    s_waitcnt vmcnt(40)
    ds_write_b128 v240, v[80:83] offset:0
    ds_write_b128 v240, v[84:87] offset:1024
    ds_write_b128 v240, v[88:91] offset:2048
    ds_write_b128 v240, v[92:95] offset:3072
    ds_write_b128 v240, v[96:99] offset:4096
    ds_write_b128 v240, v[100:103] offset:5120
    ds_write_b128 v240, v[104:107] offset:6144
    ds_write_b128 v240, v[108:111] offset:7168
    s_waitcnt vmcnt(32)
    ds_write_b128 v241, v[112:115] offset:16384
    ds_write_b128 v241, v[116:119] offset:17408
    ds_write_b128 v241, v[120:123] offset:18432
    ds_write_b128 v241, v[124:127] offset:19456
    ds_write_b128 v241, v[128:131] offset:20480
    ds_write_b128 v241, v[132:135] offset:21504
    ds_write_b128 v241, v[136:139] offset:22528
    ds_write_b128 v241, v[140:143] offset:23552
L_nd_1:
    s_waitcnt vmcnt(48)
    s_waitcnt lgkmcnt(0)
    s_barrier
    s_cmp_eq_u32 s55, 0
    s_cbranch_scc1 L_nd_2
    s_waitcnt vmcnt(24)
    ds_write_b128 v240, v[176:179] offset:16384
    ds_write_b128 v240, v[180:183] offset:17408
    ds_write_b128 v240, v[184:187] offset:18432
    ds_write_b128 v240, v[188:191] offset:19456
    ds_write_b128 v240, v[192:195] offset:20480
    ds_write_b128 v240, v[196:199] offset:21504
    ds_write_b128 v240, v[200:203] offset:22528
    ds_write_b128 v240, v[204:207] offset:23552
    s_waitcnt vmcnt(16)
    ds_write_b128 v240, v[208:211] offset:32768
    ds_write_b128 v240, v[212:215] offset:33792
    ds_write_b128 v240, v[216:219] offset:34816
    ds_write_b128 v240, v[220:223] offset:35840
    ds_write_b128 v240, v[224:227] offset:36864
    ds_write_b128 v240, v[228:231] offset:37888
    ds_write_b128 v240, v[232:235] offset:38912
    ds_write_b128 v240, v[236:239] offset:39936
L_nd_2:
    s_cmp_ge_u32 s67, 5
    s_cselect_b32 s81, 589824, 0
    s_sub_u32 s81, 221184, s81
    s_add_u32 s44, s76, s81
    s_add_u32 s44, s44, 16384
    buffer_load_dwordx4 v[80:83], v252, s[36:39], s44 offen sc1
    s_add_u32 s44, s76, s81
    s_add_u32 s44, s44, 24576
    buffer_load_dwordx4 v[84:87], v252, s[36:39], s44 offen sc1
    s_add_u32 s44, s76, s81
    s_add_u32 s44, s44, 32768
    buffer_load_dwordx4 v[88:91], v252, s[36:39], s44 offen sc1
    s_add_u32 s44, s76, s81
    s_add_u32 s44, s44, 40960
    buffer_load_dwordx4 v[92:95], v252, s[36:39], s44 offen sc1
    s_add_u32 s44, s76, s81
    s_add_u32 s44, s44, 49152
    buffer_load_dwordx4 v[96:99], v252, s[36:39], s44 offen sc1
    s_add_u32 s44, s76, s81
    s_add_u32 s44, s44, 57344
    buffer_load_dwordx4 v[100:103], v252, s[36:39], s44 offen sc1
    s_add_u32 s44, s76, s81
    s_add_u32 s44, s44, 65536
    buffer_load_dwordx4 v[104:107], v252, s[36:39], s44 offen sc1
    s_cmp_ge_u32 s67, 4
    s_cselect_b32 s81, 589824, 0
    s_sub_u32 s81, 294912, s81
    s_add_u32 s44, s76, s81
    buffer_load_dwordx4 v[108:111], v252, s[36:39], s44 offen sc1
    s_add_u32 s44, s76, s81
    s_add_u32 s44, s44, 8192
    buffer_load_dwordx4 v[112:115], v252, s[36:39], s44 offen sc1
    s_add_u32 s44, s76, s81
    s_add_u32 s44, s44, 16384
    buffer_load_dwordx4 v[116:119], v252, s[36:39], s44 offen sc1
    s_add_u32 s44, s76, s81
    s_add_u32 s44, s44, 24576
    buffer_load_dwordx4 v[120:123], v252, s[36:39], s44 offen sc1
    s_add_u32 s44, s76, s81
    s_add_u32 s44, s44, 32768
    buffer_load_dwordx4 v[124:127], v252, s[36:39], s44 offen sc1
    s_add_u32 s44, s76, s81
    s_add_u32 s44, s44, 40960
    buffer_load_dwordx4 v[128:131], v252, s[36:39], s44 offen sc1
    s_add_u32 s44, s76, s81
    s_add_u32 s44, s44, 49152
    buffer_load_dwordx4 v[132:135], v252, s[36:39], s44 offen sc1
    s_add_u32 s44, s76, s81
    s_add_u32 s44, s44, 57344
    buffer_load_dwordx4 v[136:139], v252, s[36:39], s44 offen sc1
    s_add_u32 s44, s76, s81
    s_add_u32 s44, s44, 65536
    buffer_load_dwordx4 v[140:143], v252, s[36:39], s44 offen sc1
    s_cmp_ge_u32 s67, 3
    s_cselect_b32 s81, 589824, 0
    s_sub_u32 s81, 368640, s81
    s_lshr_b32 s44, s50, 1
    s_add_u32 m0, s44, 98304
    s_add_u32 s44, s77, s81
    buffer_load_dwordx4 v252, s[36:39], s44 offen offset:0 sc1 lds
    buffer_load_dwordx4 v252, s[36:39], s44 offen offset:1024 sc1 lds
    s_lshr_b32 s44, s50, 1
    s_add_u32 m0, s44, 106496
    s_add_u32 s44, s77, s81
    s_add_u32 s44, s44, 8192
    buffer_load_dwordx4 v252, s[36:39], s44 offen offset:0 sc1 lds
    buffer_load_dwordx4 v252, s[36:39], s44 offen offset:1024 sc1 lds
    s_mov_b32 s44, 65536
    s_add_u32 m0, s50, 131072
    s_nop 0
    buffer_load_dwordx4 v148, s[24:27], s44 offen offset:0 nt lds
    buffer_load_dwordx4 v148, s[24:27], s44 offen offset:1024 nt lds
    buffer_load_dwordx4 v149, s[24:27], s44 offen offset:2048 nt lds
    buffer_load_dwordx4 v149, s[24:27], s44 offen offset:3072 nt lds
    s_waitcnt lgkmcnt(0)
    s_barrier
    s_cmp_ge_u32 s67, 8
    s_cselect_b32 s81, 0xfff70000, 0
    s_add_u32 s44, s76, s81
    s_add_u32 s44, s44, 65536
    buffer_load_dwordx4 v[248:251], v252, s[36:39], s44 offen sc1
    s_cmp_ge_u32 s67, 7
    s_cselect_b32 s81, 589824, 0
    s_sub_u32 s81, 73728, s81
    s_add_u32 s44, s76, s81
    buffer_load_dwordx4 v[0:3], v252, s[36:39], s44 offen sc1
    s_add_u32 s44, s76, s81
    s_add_u32 s44, s44, 8192
    buffer_load_dwordx4 v[4:7], v252, s[36:39], s44 offen sc1
    s_add_u32 s44, s76, s81
    s_add_u32 s44, s44, 16384
    buffer_load_dwordx4 v[8:11], v252, s[36:39], s44 offen sc1
    s_add_u32 s44, s76, s81
    s_add_u32 s44, s44, 24576
    buffer_load_dwordx4 v[12:15], v252, s[36:39], s44 offen sc1
    s_mov_b32 s44, 65536
    s_add_u32 m0, s50, 147456
    s_nop 0
    buffer_load_dwordx4 v150, s[28:31], s44 offen offset:0 nt lds
    buffer_load_dwordx4 v150, s[28:31], s44 offen offset:1024 nt lds
    buffer_load_dwordx4 v151, s[28:31], s44 offen offset:2048 nt lds
    buffer_load_dwordx4 v151, s[28:31], s44 offen offset:3072 nt lds
    s_mov_b32 s44, 81920
    s_add_u32 m0, s50, 0
    s_nop 0
    buffer_load_dwordx4 v148, s[24:27], s44 offen offset:0 nt lds
    buffer_load_dwordx4 v148, s[24:27], s44 offen offset:1024 nt lds
    buffer_load_dwordx4 v149, s[24:27], s44 offen offset:2048 nt lds
    buffer_load_dwordx4 v149, s[24:27], s44 offen offset:3072 nt lds
    s_cmp_eq_u32 s55, 0
    s_cbranch_scc1 L_nd_3
    s_waitcnt vmcnt(45)
    ds_write_b128 v240, v[16:19] offset:49152
    ds_write_b128 v240, v[20:23] offset:50176
    ds_write_b128 v240, v[24:27] offset:51200
    ds_write_b128 v240, v[28:31] offset:52224
    ds_write_b128 v240, v[32:35] offset:53248
    ds_write_b128 v240, v[36:39] offset:54272
    ds_write_b128 v240, v[40:43] offset:55296
    ds_write_b128 v240, v[44:47] offset:56320
    s_waitcnt vmcnt(37)
    ds_write_b128 v241, v[48:51] offset:0
    ds_write_b128 v241, v[52:55] offset:1024
    ds_write_b128 v241, v[56:59] offset:2048
    ds_write_b128 v241, v[60:63] offset:3072
    ds_write_b128 v241, v[64:67] offset:4096
    ds_write_b128 v241, v[68:71] offset:5120
    ds_write_b128 v241, v[72:75] offset:6144
    ds_write_b128 v241, v[76:79] offset:7168
L_nd_3:
    s_waitcnt lgkmcnt(0)
    s_barrier
    s_cmp_ge_u32 s67, 8
    s_cselect_b32 s81, 0xfff70000, 0
    s_add_u32 s44, s76, s81
    buffer_load_dwordx4 v[192:195], v252, s[36:39], s44 offen sc1
    s_add_u32 s44, s76, s81
    s_add_u32 s44, s44, 8192
    buffer_load_dwordx4 v[204:207], v252, s[36:39], s44 offen sc1
    s_add_u32 s44, s76, s81
    s_add_u32 s44, s44, 16384
    buffer_load_dwordx4 v[216:219], v252, s[36:39], s44 offen sc1
    s_add_u32 s44, s76, s81
    s_add_u32 s44, s44, 24576
    buffer_load_dwordx4 v[228:231], v252, s[36:39], s44 offen sc1
    s_mov_b32 s44, 81920
    s_add_u32 m0, s50, 81920
    s_nop 0
    buffer_load_dwordx4 v150, s[28:31], s44 offen offset:0 nt lds
    buffer_load_dwordx4 v150, s[28:31], s44 offen offset:1024 nt lds
    buffer_load_dwordx4 v151, s[28:31], s44 offen offset:2048 nt lds
    buffer_load_dwordx4 v151, s[28:31], s44 offen offset:3072 nt lds
    s_mov_b32 s44, 98304
    s_add_u32 m0, s50, 16384
    s_nop 0
    buffer_load_dwordx4 v148, s[24:27], s44 offen offset:0 nt lds
    buffer_load_dwordx4 v148, s[24:27], s44 offen offset:1024 nt lds
    buffer_load_dwordx4 v149, s[24:27], s44 offen offset:2048 nt lds
    buffer_load_dwordx4 v149, s[24:27], s44 offen offset:3072 nt lds
    s_waitcnt vmcnt(25)
    s_barrier
    s_cmp_ge_u32 s67, 3
    s_cselect_b32 s81, 589824, 0
    s_sub_u32 s81, 368640, s81
    s_lshr_b32 s44, s50, 1
    s_add_u32 m0, s44, 114688
    s_add_u32 s44, s77, s81
    s_add_u32 s44, s44, 16384
    buffer_load_dwordx4 v252, s[36:39], s44 offen offset:0 sc1 lds
    buffer_load_dwordx4 v252, s[36:39], s44 offen offset:1024 sc1 lds
    s_lshr_b32 s44, s50, 1
    s_add_u32 m0, s44, 122880
    s_add_u32 s44, s77, s81
    s_add_u32 s44, s44, 24576
    buffer_load_dwordx4 v252, s[36:39], s44 offen offset:0 sc1 lds
    buffer_load_dwordx4 v252, s[36:39], s44 offen offset:1024 sc1 lds
    s_mov_b32 s44, 98304
    s_add_u32 m0, s50, 32768
    s_nop 0
    buffer_load_dwordx4 v150, s[28:31], s44 offen offset:0 nt lds
    buffer_load_dwordx4 v150, s[28:31], s44 offen offset:1024 nt lds
    buffer_load_dwordx4 v151, s[28:31], s44 offen offset:2048 nt lds
    buffer_load_dwordx4 v151, s[28:31], s44 offen offset:3072 nt lds
    s_mov_b32 s44, 114688
    s_add_u32 m0, s50, 49152
    s_nop 0
    buffer_load_dwordx4 v148, s[24:27], s44 offen offset:0 nt lds
    buffer_load_dwordx4 v148, s[24:27], s44 offen offset:1024 nt lds
    buffer_load_dwordx4 v149, s[24:27], s44 offen offset:2048 nt lds
    buffer_load_dwordx4 v149, s[24:27], s44 offen offset:3072 nt lds
    s_waitcnt vmcnt(24)
    s_barrier
    s_lshr_b32 s44, s50, 1
    s_add_u32 m0, s44, 131072
    s_add_u32 s44, s77, s81
    s_add_u32 s44, s44, 32768
    buffer_load_dwordx4 v252, s[36:39], s44 offen offset:0 sc1 lds
    buffer_load_dwordx4 v252, s[36:39], s44 offen offset:1024 sc1 lds
    s_lshr_b32 s44, s50, 1
    s_add_u32 m0, s44, 139264
    s_add_u32 s44, s77, s81
    s_add_u32 s44, s44, 40960
    buffer_load_dwordx4 v252, s[36:39], s44 offen offset:0 sc1 lds
    buffer_load_dwordx4 v252, s[36:39], s44 offen offset:1024 sc1 lds
    s_mov_b32 s44, 114688
    s_add_u32 m0, s50, 65536
    s_nop 0
    buffer_load_dwordx4 v150, s[28:31], s44 offen offset:0 nt lds
    buffer_load_dwordx4 v150, s[28:31], s44 offen offset:1024 nt lds
    buffer_load_dwordx4 v151, s[28:31], s44 offen offset:2048 nt lds
    buffer_load_dwordx4 v151, s[28:31], s44 offen offset:3072 nt lds
    s_cmp_ge_u32 s67, 8
    s_cselect_b32 s81, 0xfff70000, 0
    s_add_u32 s44, s76, s81
    s_add_u32 s44, s44, 32768
    buffer_load_dwordx4 v[196:199], v252, s[36:39], s44 offen sc1
    s_add_u32 s44, s76, s81
    s_add_u32 s44, s44, 40960
    buffer_load_dwordx4 v[208:211], v252, s[36:39], s44 offen sc1
    s_add_u32 s44, s76, s81
    s_add_u32 s44, s44, 49152
    buffer_load_dwordx4 v[220:223], v252, s[36:39], s44 offen sc1
    s_add_u32 s44, s76, s81
    s_add_u32 s44, s44, 57344
    buffer_load_dwordx4 v[232:235], v252, s[36:39], s44 offen sc1
    s_waitcnt vmcnt(24)
    s_barrier
    s_cmp_ge_u32 s67, 7
    s_cselect_b32 s81, 589824, 0
    s_sub_u32 s81, 73728, s81
    s_add_u32 s44, s76, s81
    s_add_u32 s44, s44, 32768
    buffer_load_dwordx4 v[16:19], v252, s[36:39], s44 offen sc1
    s_add_u32 s44, s76, s81
    s_add_u32 s44, s44, 40960
    buffer_load_dwordx4 v[20:23], v252, s[36:39], s44 offen sc1
    s_add_u32 s44, s76, s81
    s_add_u32 s44, s44, 49152
    buffer_load_dwordx4 v[24:27], v252, s[36:39], s44 offen sc1
    s_add_u32 s44, s76, s81
    s_add_u32 s44, s44, 57344
    buffer_load_dwordx4 v[28:31], v252, s[36:39], s44 offen sc1
    s_add_u32 s44, s76, s81
    s_add_u32 s44, s44, 65536
    buffer_load_dwordx4 v[32:35], v252, s[36:39], s44 offen sc1
    s_cmp_ge_u32 s67, 6
    s_cselect_b32 s81, 589824, 0
    s_sub_u32 s81, 147456, s81
    s_add_u32 s44, s76, s81
    buffer_load_dwordx4 v[36:39], v252, s[36:39], s44 offen sc1
    s_cmp_ge_u32 s67, 3
    s_cselect_b32 s81, 589824, 0
    s_sub_u32 s81, 368640, s81
    s_lshr_b32 s44, s50, 1
    s_add_u32 m0, s44, 147456
    s_add_u32 s44, s77, s81
    s_add_u32 s44, s44, 49152
    buffer_load_dwordx4 v252, s[36:39], s44 offen offset:0 sc1 lds
    buffer_load_dwordx4 v252, s[36:39], s44 offen offset:1024 sc1 lds
    s_lshr_b32 s44, s50, 1
    s_add_u32 m0, s44, 155648
    s_add_u32 s44, s77, s81
    s_add_u32 s44, s44, 57344
    buffer_load_dwordx4 v252, s[36:39], s44 offen offset:0 sc1 lds
    buffer_load_dwordx4 v252, s[36:39], s44 offen offset:1024 sc1 lds
    s_lshr_b32 s44, s50, 1
    s_add_u32 m0, s44, 0
    s_add_u32 s44, s77, s81
    s_add_u32 s44, s44, 65536
    buffer_load_dwordx4 v252, s[36:39], s44 offen offset:0 sc1 lds
    buffer_load_dwordx4 v252, s[36:39], s44 offen offset:1024 sc1 lds
    s_cmp_ge_u32 s67, 2
    s_cselect_b32 s81, 589824, 0
    s_sub_u32 s81, 442368, s81
    s_lshr_b32 s44, s50, 1
    s_add_u32 m0, s44, 8192
    s_add_u32 s44, s77, s81
    buffer_load_dwordx4 v252, s[36:39], s44 offen offset:0 sc1 lds
    buffer_load_dwordx4 v252, s[36:39], s44 offen offset:1024 sc1 lds
    s_waitcnt vmcnt(26)
    s_barrier
    s_cmp_ge_u32 s67, 6
    s_cselect_b32 s81, 589824, 0
    s_sub_u32 s81, 147456, s81
    s_add_u32 s44, s76, s81
    s_add_u32 s44, s44, 8192
    buffer_load_dwordx4 v[40:43], v252, s[36:39], s44 offen sc1
    s_add_u32 s44, s76, s81
    s_add_u32 s44, s44, 16384
    buffer_load_dwordx4 v[44:47], v252, s[36:39], s44 offen sc1
    s_add_u32 s44, s76, s81
    s_add_u32 s44, s44, 24576
    buffer_load_dwordx4 v[48:51], v252, s[36:39], s44 offen sc1
    s_add_u32 s44, s76, s81
    s_add_u32 s44, s44, 32768
    buffer_load_dwordx4 v[52:55], v252, s[36:39], s44 offen sc1
    s_add_u32 s44, s76, s81
    s_add_u32 s44, s44, 40960
    buffer_load_dwordx4 v[56:59], v252, s[36:39], s44 offen sc1
    s_add_u32 s44, s76, s81
    s_add_u32 s44, s44, 49152
    buffer_load_dwordx4 v[60:63], v252, s[36:39], s44 offen sc1
    s_add_u32 s44, s76, s81
    s_add_u32 s44, s44, 57344
    buffer_load_dwordx4 v[64:67], v252, s[36:39], s44 offen sc1
    s_cmp_ge_u32 s67, 2
    s_cselect_b32 s81, 589824, 0
    s_sub_u32 s81, 442368, s81
    s_lshr_b32 s44, s50, 1
    s_add_u32 m0, s44, 81920
    s_add_u32 s44, s77, s81
    s_add_u32 s44, s44, 8192
    buffer_load_dwordx4 v252, s[36:39], s44 offen offset:0 sc1 lds
    buffer_load_dwordx4 v252, s[36:39], s44 offen offset:1024 sc1 lds
    s_lshr_b32 s44, s50, 1
    s_add_u32 m0, s44, 90112
    s_add_u32 s44, s77, s81
    s_add_u32 s44, s44, 16384
    buffer_load_dwordx4 v252, s[36:39], s44 offen offset:0 sc1 lds
    buffer_load_dwordx4 v252, s[36:39], s44 offen offset:1024 sc1 lds
    s_lshr_b32 s44, s50, 1
    s_add_u32 m0, s44, 16384
    s_add_u32 s44, s77, s81
    s_add_u32 s44, s44, 24576
    buffer_load_dwordx4 v252, s[36:39], s44 offen offset:0 sc1 lds
    buffer_load_dwordx4 v252, s[36:39], s44 offen offset:1024 sc1 lds
    s_lshr_b32 s44, s50, 1
    s_add_u32 m0, s44, 24576
    s_add_u32 s44, s77, s81
    s_add_u32 s44, s44, 32768
    buffer_load_dwordx4 v252, s[36:39], s44 offen offset:0 sc1 lds
    buffer_load_dwordx4 v252, s[36:39], s44 offen offset:1024 sc1 lds
    s_add_u32 s44, s77, s81
    s_add_u32 s44, s44, 57344
    buffer_load_dwordx4 v[180:183], v252, s[36:39], s44 offen offset:0 sc1
    buffer_load_dwordx4 v[184:187], v252, s[36:39], s44 offen offset:1024 sc1
    s_add_u32 s44, s77, s81
    s_add_u32 s44, s44, 65536
    buffer_load_dwordx4 v[188:191], v252, s[36:39], s44 offen offset:0 sc1
    buffer_load_dwordx4 v[200:203], v252, s[36:39], s44 offen offset:1024 sc1
    s_waitcnt vmcnt(37)
    s_barrier
    s_cmp_ge_u32 s67, 6
    s_cselect_b32 s81, 589824, 0
    s_sub_u32 s81, 147456, s81
    s_add_u32 s44, s76, s81
    s_add_u32 s44, s44, 65536
    buffer_load_dwordx4 v[68:71], v252, s[36:39], s44 offen sc1
    s_cmp_ge_u32 s67, 5
    s_cselect_b32 s81, 589824, 0
    s_sub_u32 s81, 221184, s81
    s_add_u32 s44, s76, s81
    buffer_load_dwordx4 v[72:75], v252, s[36:39], s44 offen sc1
    s_add_u32 s44, s76, s81
    s_add_u32 s44, s44, 8192
    buffer_load_dwordx4 v[76:79], v252, s[36:39], s44 offen sc1
    s_cmp_ge_u32 s67, 2
    s_cselect_b32 s81, 589824, 0
    s_sub_u32 s81, 442368, s81
    s_lshr_b32 s44, s50, 1
    s_add_u32 m0, s44, 32768
    s_add_u32 s44, s77, s81
    s_add_u32 s44, s44, 40960
    buffer_load_dwordx4 v252, s[36:39], s44 offen offset:0 sc1 lds
    buffer_load_dwordx4 v252, s[36:39], s44 offen offset:1024 sc1 lds
    s_lshr_b32 s44, s50, 1
    s_add_u32 m0, s44, 40960
    s_add_u32 s44, s77, s81
    s_add_u32 s44, s44, 49152
    buffer_load_dwordx4 v252, s[36:39], s44 offen offset:0 sc1 lds
    buffer_load_dwordx4 v252, s[36:39], s44 offen offset:1024 sc1 lds
    s_cmp_ge_u32 s67, 1
    s_cselect_b32 s81, 589824, 0
    s_sub_u32 s81, 516096, s81
    s_add_u32 s44, s77, s81
    buffer_load_dwordx4 v[212:215], v252, s[36:39], s44 offen offset:0 sc1
    buffer_load_dwordx4 v[224:227], v252, s[36:39], s44 offen offset:1024 sc1
    s_add_u32 s44, s77, s81
    s_add_u32 s44, s44, 8192
    buffer_load_dwordx4 v[236:239], v252, s[36:39], s44 offen offset:0 sc1
    buffer_load_dwordx4 v[244:247], v252, s[36:39], s44 offen offset:1024 sc1
    s_barrier
    v_mov_b32 v152, 49152
    ds_read_b128 v[152:155], v152
    s_waitcnt lgkmcnt(0)
    v_or3_b32 v152, v152, v153, v154
    v_or_b32 v152, v152, v155
    s_nop 0
    v_readfirstlane_b32 s44, v152
    s_nop 0
    s_cmp_lg_u32 s44, 0
    s_cbranch_scc1 L_h_redo
    s_lshr_b32 s44, s50, 1
    s_add_u32 s44, s44, 65536
    v_add_u32 v156, s44, v252
    s_waitcnt vmcnt(0)
    ds_write_b128 v156, v[212:215] offset:0
    ds_write_b128 v156, v[224:227] offset:1024
    ds_write_b128 v156, v[236:239] offset:8192
    ds_write_b128 v156, v[244:247] offset:9216
    s_barrier
    s_cmp_lg_u32 s40, 0
    s_cbranch_scc1 L_h_nosig
    s_lshl_b32 s44, s41, 5
    s_add_u32 s44, s44, s42
    s_lshl_b32 s44, s44, 8
    s_add_u32 s44, s44, 16777216
    s_mov_b64 exec, 1
    buffer_store_dwordx2 v[144:145], v146, s[36:39], s44 offen sc1
    s_mov_b64 exec, -1
L_h_nosig:
    s_lshr_b32 s44, s50, 1
    s_add_u32 s44, s44, 49152
    v_add_u32 v156, s44, v252
    ds_write_b128 v156, v[180:183] offset:0
    ds_write_b128 v156, v[184:187] offset:1024
    ds_write_b128 v156, v[188:191] offset:8192
    ds_write_b128 v156, v[200:203] offset:9216
    s_waitcnt lgkmcnt(0)
    s_setprio 0
    s_cmp_lg_u32 s40, 1
    s_cbranch_scc1 L_h_np
    s_lshr_b32 s44, s74, 2
    s_lshl_b32 s44, s44, 13
    s_add_u32 s44, s44, 16777216
    s_mov_b32 s47, 0
L_h_poll:
    buffer_load_dwordx2 v[152:153], v146, s[36:39], s44 offen sc1
    s_add_u32 s47, s47, 1
    s_waitcnt vmcnt(0)
    v_cmp_ne_u64 vcc, v[152:153], v[144:145]
    s_cbranch_vccz L_op
    s_sleep 1
    s_cmp_lt_u32 s47, 0x100000
    s_cbranch_scc1 L_h_poll
L_h_np:
    s_waitcnt vmcnt(0)
    s_branch L_op
L_h_redo:
    s_waitcnt vmcnt(0)
    s_barrier
    s_mov_b32 s44, 0
    s_add_u32 m0, s50, 131072
    s_nop 0
    buffer_load_dwordx4 v148, s[24:27], s44 offen offset:0 nt lds
    buffer_load_dwordx4 v148, s[24:27], s44 offen offset:1024 nt lds
    buffer_load_dwordx4 v149, s[24:27], s44 offen offset:2048 nt lds
    buffer_load_dwordx4 v149, s[24:27], s44 offen offset:3072 nt lds
    s_add_u32 m0, s50, 147456
    s_nop 0
    buffer_load_dwordx4 v150, s[28:31], s44 offen offset:0 nt lds
    buffer_load_dwordx4 v150, s[28:31], s44 offen offset:1024 nt lds
    buffer_load_dwordx4 v151, s[28:31], s44 offen offset:2048 nt lds
    buffer_load_dwordx4 v151, s[28:31], s44 offen offset:3072 nt lds
    s_mov_b32 s44, 16384
    s_add_u32 m0, s50, 0
    s_nop 0
    buffer_load_dwordx4 v148, s[24:27], s44 offen offset:0 nt lds
    buffer_load_dwordx4 v148, s[24:27], s44 offen offset:1024 nt lds
    buffer_load_dwordx4 v149, s[24:27], s44 offen offset:2048 nt lds
    buffer_load_dwordx4 v149, s[24:27], s44 offen offset:3072 nt lds
    s_add_u32 m0, s50, 81920
    s_nop 0
    buffer_load_dwordx4 v150, s[28:31], s44 offen offset:0 nt lds
    buffer_load_dwordx4 v150, s[28:31], s44 offen offset:1024 nt lds
    buffer_load_dwordx4 v151, s[28:31], s44 offen offset:2048 nt lds
    buffer_load_dwordx4 v151, s[28:31], s44 offen offset:3072 nt lds
    s_mov_b32 s44, 32768
    s_add_u32 m0, s50, 16384
    s_nop 0
    buffer_load_dwordx4 v148, s[24:27], s44 offen offset:0 nt lds
    buffer_load_dwordx4 v148, s[24:27], s44 offen offset:1024 nt lds
    buffer_load_dwordx4 v149, s[24:27], s44 offen offset:2048 nt lds
    buffer_load_dwordx4 v149, s[24:27], s44 offen offset:3072 nt lds
    s_add_u32 m0, s50, 32768
    s_nop 0
    buffer_load_dwordx4 v150, s[28:31], s44 offen offset:0 nt lds
    buffer_load_dwordx4 v150, s[28:31], s44 offen offset:1024 nt lds
    buffer_load_dwordx4 v151, s[28:31], s44 offen offset:2048 nt lds
    buffer_load_dwordx4 v151, s[28:31], s44 offen offset:3072 nt lds
    s_mov_b32 s44, 49152
    s_add_u32 m0, s50, 49152
    s_nop 0
    buffer_load_dwordx4 v148, s[24:27], s44 offen offset:0 nt lds
    buffer_load_dwordx4 v148, s[24:27], s44 offen offset:1024 nt lds
    buffer_load_dwordx4 v149, s[24:27], s44 offen offset:2048 nt lds
    buffer_load_dwordx4 v149, s[24:27], s44 offen offset:3072 nt lds
    s_add_u32 m0, s50, 65536
    s_nop 0
    buffer_load_dwordx4 v150, s[28:31], s44 offen offset:0 nt lds
    buffer_load_dwordx4 v150, s[28:31], s44 offen offset:1024 nt lds
    buffer_load_dwordx4 v151, s[28:31], s44 offen offset:2048 nt lds
    buffer_load_dwordx4 v151, s[28:31], s44 offen offset:3072 nt lds
    s_mov_b32 s55, 0
    s_waitcnt vmcnt(0)
    s_branch L_h9
L_compute:
    s_setprio 3
    v_mov_b32 v235, v1
    s_sub_u32 s46, s40, 4
    v_and_b32 v192, 15, v235
    v_lshrrev_b32 v194, 4, v235
    s_mul_i32 s44, s46, 6144
    v_lshl_add_u32 v193, v192, 7, s44
    v_lshrrev_b32 v195, 1, v192
    v_xor_b32 v195, v195, v194
    v_lshl_add_u32 v92, v195, 4, v193
    v_xor_b32 v93, 64, v92
    v_and_b32 v193, 3, v192
    v_lshrrev_b32 v195, 2, v192
    v_lshl_add_u32 v193, v195, 3, v193
    v_lshlrev_b32 v193, 8, v193
    v_xor_b32 v195, v192, v194
    v_lshl_add_u32 v94, v195, 4, v193
    v_bfe_u32 v196, v235, 2, 2
    v_and_b32 v197, 3, v235
    v_lshl_add_u32 v193, v194, 3, v196
    v_lshlrev_b32 v193, 8, v193
    v_and_b32 v192, 1, v194
    v_lshl_or_b32 v195, v192, 2, v196
    v_lshlrev_b32 v195, 5, v195
    v_lshl_or_b32 v195, v197, 3, v195
    v_add_u32 v95, v195, v193
    v_and_b32 v195, 1, v196
    v_xor_b32 v195, v195, v197
    v_lshrrev_b32 v198, 1, v196
    v_lshl_or_b32 v195, v198, 2, v195
    v_lshl_or_b32 v195, v192, 3, v195
    v_lshlrev_b32 v195, 4, v195
    v_and_b32 v198, 1, v197
    v_lshl_or_b32 v195, v198, 3, v195
    v_add_u32 v195, v195, v193
    v_add_u32 v195, 106496, v195
    v_xor_b32 v248, 0, v195
    v_xor_b32 v249, 8, v195
    v_xor_b32 v250, 64, v195
    v_xor_b32 v251, 72, v195
    v_xor_b32 v252, 128, v195
    v_xor_b32 v253, 136, v195
    v_xor_b32 v254, 192, v195
    v_xor_b32 v255, 200, v195
    v_cmp_eq_u32 s[68:69], 1, v192
    s_mov_b32 s57, 0x4b800000
    s_mov_b32 s58, 0x3e0293ee
    s_mov_b32 s62, 0
    s_mov_b32 s49, 4
    s_mov_b32 s50, 0
    s_mov_b32 s47, 9
    s_mul_i32 s59, s41, 12
    s_mul_i32 s44, s46, 3
    s_add_u32 s59, s59, s44
    s_lshl_b32 s59, s59, 5
    s_add_u32 s59, s59, s42
    s_lshl_b32 s59, s59, 12
    s_add_u32 s60, s59, 131072
    s_add_u32 s61, s59, 262144
    s_waitcnt lgkmcnt(0)
    s_mov_b32 s36, s18
    s_mov_b32 s37, s19
    s_mov_b32 s38, 0x10000000
    s_mov_b32 s39, 0x00020000
    s_and_b32 s74, s2, 6
    s_lshl_b32 s74, s74, 2
    s_bfe_u32 s44, s2, 0x30003
    s_add_u32 s74, s74, s44
    s_lshr_b32 s75, s2, 6
    s_and_b32 s44, s2, 1
    s_lshl_b32 s44, s44, 2
    s_add_u32 s75, s75, s44
    s_and_b32 s44, s74, 3
    s_mul_i32 s44, s44, 0
    s_mul_i32 s67, s75, 0
    s_add_u32 s67, s67, s44
    s_and_b32 s67, s67, 0
    s_and_b32 s45, s74, 0
    s_lshl_b32 s45, s45, 2
    s_xor_b32 s66, s45, s40
    s_mul_i32 s77, s75, 589824
    s_add_u32 s77, s77, 20971520
    s_mul_i32 s44, s67, 73728
    s_add_u32 s77, s77, s44
    s_lshl_b32 s44, s66, 10
    s_add_u32 s76, s77, s44
    s_lshl_b32 s44, s40, 11
    s_add_u32 s77, s77, s44
    s_mul_i32 s78, s74, 393216
    s_lshl_b32 s44, s66, 11
    s_add_u32 s78, s78, s44
    s_lshl_b32 s44, s67, 14
    s_add_u32 s78, s78, s44
    s_add_u32 s79, s78, 131072
    s_add_u32 s80, s78, 262144
    v_pk_mov_b32 v[6:7], 0, 0
    v_pk_mov_b32 v[8:9], 0, 0
    v_pk_mov_b32 v[10:11], 0, 0
    v_pk_mov_b32 v[12:13], 0, 0
    v_pk_mov_b32 v[14:15], 0, 0
    v_pk_mov_b32 v[16:17], 0, 0
    v_pk_mov_b32 v[18:19], 0, 0
    v_pk_mov_b32 v[20:21], 0, 0
    v_pk_mov_b32 v[22:23], 0, 0
    v_pk_mov_b32 v[24:25], 0, 0
    v_pk_mov_b32 v[26:27], 0, 0
    v_pk_mov_b32 v[28:29], 0, 0
    v_pk_mov_b32 v[30:31], 0, 0
    v_pk_mov_b32 v[32:33], 0, 0
    v_pk_mov_b32 v[34:35], 0, 0
    v_pk_mov_b32 v[36:37], 0, 0
    v_pk_mov_b32 v[38:39], 0, 0
    v_pk_mov_b32 v[40:41], 0, 0
    v_pk_mov_b32 v[42:43], 0, 0
    v_pk_mov_b32 v[44:45], 0, 0
    v_pk_mov_b32 v[46:47], 0, 0
    v_pk_mov_b32 v[48:49], 0, 0
    v_pk_mov_b32 v[50:51], 0, 0
    v_pk_mov_b32 v[52:53], 0, 0
    v_pk_mov_b32 v[54:55], 0, 0
    v_pk_mov_b32 v[56:57], 0, 0
    v_pk_mov_b32 v[58:59], 0, 0
    v_pk_mov_b32 v[60:61], 0, 0
    v_pk_mov_b32 v[62:63], 0, 0
    v_pk_mov_b32 v[64:65], 0, 0
    v_pk_mov_b32 v[66:67], 0, 0
    v_pk_mov_b32 v[68:69], 0, 0
    v_pk_mov_b32 v[70:71], 0, 0
    v_pk_mov_b32 v[72:73], 0, 0
    v_pk_mov_b32 v[74:75], 0, 0
    v_pk_mov_b32 v[76:77], 0, 0
    v_pk_mov_b32 v[78:79], 0, 0
    v_pk_mov_b32 v[80:81], 0, 0
    v_pk_mov_b32 v[82:83], 0, 0
    v_pk_mov_b32 v[84:85], 0, 0
    v_pk_mov_b32 v[86:87], 0, 0
    v_pk_mov_b32 v[88:89], 0, 0
    v_pk_mov_b32 v[90:91], 0, 0
    v_pk_mov_b32 v[96:97], 0, 0
    v_pk_mov_b32 v[98:99], 0, 0
    v_pk_mov_b32 v[100:101], 0, 0
    v_pk_mov_b32 v[102:103], 0, 0
    v_pk_mov_b32 v[104:105], 0, 0
    v_pk_mov_b32 v[106:107], 0, 0
    v_pk_mov_b32 v[108:109], 0, 0
    v_pk_mov_b32 v[110:111], 0, 0
    v_pk_mov_b32 v[112:113], 0, 0
    v_pk_mov_b32 v[114:115], 0, 0
    v_pk_mov_b32 v[116:117], 0, 0
    v_pk_mov_b32 v[118:119], 0, 0
    v_pk_mov_b32 v[120:121], 0, 0
    v_pk_mov_b32 v[122:123], 0, 0
    v_pk_mov_b32 v[124:125], 0, 0
    v_pk_mov_b32 v[126:127], 0, 0
    v_pk_mov_b32 v[128:129], 0, 0
    v_pk_mov_b32 v[130:131], 0, 0
    v_pk_mov_b32 v[132:133], 0, 0
    v_pk_mov_b32 v[134:135], 0, 0
    v_pk_mov_b32 v[136:137], 0, 0
    v_pk_mov_b32 v[138:139], 0, 0
    v_pk_mov_b32 v[140:141], 0, 0
    v_pk_mov_b32 v[142:143], 0, 0
    v_pk_mov_b32 v[144:145], 0, 0
    v_pk_mov_b32 v[146:147], 0, 0
    v_pk_mov_b32 v[148:149], 0, 0
    v_pk_mov_b32 v[150:151], 0, 0
    v_pk_mov_b32 v[152:153], 0, 0
    v_pk_mov_b32 v[154:155], 0, 0
    v_pk_mov_b32 v[156:157], 0, 0
    v_pk_mov_b32 v[158:159], 0, 0
    v_pk_mov_b32 v[160:161], 0, 0
    v_pk_mov_b32 v[162:163], 0, 0
    v_pk_mov_b32 v[164:165], 0, 0
    v_pk_mov_b32 v[166:167], 0, 0
    v_pk_mov_b32 v[168:169], 0, 0
    v_pk_mov_b32 v[170:171], 0, 0
    v_pk_mov_b32 v[172:173], 0, 0
    v_pk_mov_b32 v[174:175], 0, 0
    v_pk_mov_b32 v[176:177], 0, 0
    v_pk_mov_b32 v[178:179], 0, 0
    v_pk_mov_b32 v[180:181], 0, 0
    v_pk_mov_b32 v[182:183], 0, 0
    v_pk_mov_b32 v[184:185], 0, 0
    v_pk_mov_b32 v[186:187], 0, 0
    v_pk_mov_b32 v[188:189], 0, 0
    v_pk_mov_b32 v[190:191], 0, 0
    v_pk_mov_b32 v[192:193], 0, 0
    v_pk_mov_b32 v[194:195], 0, 0
    v_pk_mov_b32 v[196:197], 0, 0
    v_pk_mov_b32 v[198:199], 0, 0
    v_pk_mov_b32 v[200:201], 0, 0
    v_pk_mov_b32 v[202:203], 0, 0
    v_pk_mov_b32 v[204:205], 0, 0
    v_pk_mov_b32 v[206:207], 0, 0
    v_pk_mov_b32 v[208:209], 0, 0
    v_pk_mov_b32 v[210:211], 0, 0
    v_pk_mov_b32 v[212:213], 0, 0
    v_pk_mov_b32 v[214:215], 0, 0
    v_pk_mov_b32 v[216:217], 0, 0
    v_pk_mov_b32 v[218:219], 0, 0
    v_pk_mov_b32 v[220:221], 0, 0
    v_pk_mov_b32 v[222:223], 0, 0
    v_pk_mov_b32 v[236:237], 0, 0
    v_pk_mov_b32 v[238:239], 0, 0
    v_pk_mov_b32 v[240:241], 0, 0
    v_pk_mov_b32 v[242:243], 0, 0
    v_pk_mov_b32 v[244:245], 0, 0
    v_pk_mov_b32 v[246:247], 0, 0
    s_mov_b32 s48, 8192
    s_mov_b32 s65, 24576
L_p1:
    s_barrier
    s_add_u32 s49, s49, 1
    s_cmp_eq_u32 s49, 7
    s_cselect_b32 s51, 0xffff4000, s48
    s_cselect_b32 s49, 0, s49
    s_add_u32 s50, s50, 1
    s_cmp_eq_u32 s50, 3
    s_cselect_b32 s52, 0xffff4000, s65
    s_cselect_b32 s50, 0, s50
    s_waitcnt lgkmcnt(8)
    v_mfma_f32_16x16x32_bf16 v[124:127], v[204:207], v[236:239], v[124:127]
    ds_read_b64_tr_b16 v[192:193], v248 offset:0
    v_mfma_f32_16x16x32_bf16 v[132:135], v[204:207], v[240:243], v[132:135]
    ds_read_b64_tr_b16 v[194:195], v248 offset:1024
    v_add_u32 v248, s51, v248
    v_mfma_f32_16x16x32_bf16 v[140:143], v[204:207], v[244:247], v[140:143]
    ds_read_b128 v[224:227], v92 offset:0
    s_waitcnt lgkmcnt(9)
    v_mfma_f32_16x16x32_bf16 v[144:147], v[208:211], v[236:239], v[144:147]
    ds_read_b64_tr_b16 v[196:197], v249 offset:0
    v_mfma_f32_16x16x32_bf16 v[152:155], v[208:211], v[240:243], v[152:155]
    ds_read_b64_tr_b16 v[198:199], v249 offset:1024
    v_add_u32 v249, s51, v249
    v_mfma_f32_16x16x32_bf16 v[160:163], v[208:211], v[244:247], v[160:163]
    ds_read_b128 v[228:231], v92 offset:2048
    s_waitcnt lgkmcnt(10)
    v_mfma_f32_16x16x32_bf16 v[148:151], v[212:215], v[236:239], v[148:151]
    ds_read_b64_tr_b16 v[200:201], v250 offset:0
    v_mfma_f32_16x16x32_bf16 v[156:159], v[212:215], v[240:243], v[156:159]
    ds_read_b64_tr_b16 v[202:203], v250 offset:1024
    v_add_u32 v250, s51, v250
    v_mfma_f32_16x16x32_bf16 v[164:167], v[212:215], v[244:247], v[164:167]
    ds_read_b128 v[232:235], v92 offset:4096
    v_add_u32 v92, s52, v92
    s_waitcnt lgkmcnt(11)
    v_mfma_f32_16x16x32_bf16 v[168:171], v[216:219], v[236:239], v[168:171]
    ds_read_b64_tr_b16 v[204:205], v251 offset:0
    v_mfma_f32_16x16x32_bf16 v[176:179], v[216:219], v[240:243], v[176:179]
    ds_read_b64_tr_b16 v[206:207], v251 offset:1024
    v_add_u32 v251, s51, v251
    v_mfma_f32_16x16x32_bf16 v[184:187], v[216:219], v[244:247], v[184:187]
    s_waitcnt lgkmcnt(11)
    v_mfma_f32_16x16x32_bf16 v[172:175], v[220:223], v[236:239], v[172:175]
    ds_read_b64_tr_b16 v[208:209], v252 offset:0
    v_mfma_f32_16x16x32_bf16 v[180:183], v[220:223], v[240:243], v[180:183]
    ds_read_b64_tr_b16 v[210:211], v252 offset:1024
    v_add_u32 v252, s51, v252
    v_mfma_f32_16x16x32_bf16 v[188:191], v[220:223], v[244:247], v[188:191]
    s_waitcnt lgkmcnt(4)
    v_mfma_f32_16x16x32_bf16 v[96:99], v[192:195], v[224:227], v[96:99]
    ds_read_b64_tr_b16 v[212:213], v253 offset:0
    v_mfma_f32_16x16x32_bf16 v[104:107], v[192:195], v[228:231], v[104:107]
    ds_read_b64_tr_b16 v[214:215], v253 offset:1024
    v_add_u32 v253, s51, v253
    v_mfma_f32_16x16x32_bf16 v[112:115], v[192:195], v[232:235], v[112:115]
    s_waitcnt lgkmcnt(10)
    v_mfma_f32_16x16x32_bf16 v[100:103], v[196:199], v[224:227], v[100:103]
    ds_read_b64_tr_b16 v[216:217], v254 offset:0
    v_mfma_f32_16x16x32_bf16 v[108:111], v[196:199], v[228:231], v[108:111]
    ds_read_b64_tr_b16 v[218:219], v254 offset:1024
    v_add_u32 v254, s51, v254
    v_mfma_f32_16x16x32_bf16 v[116:119], v[196:199], v[232:235], v[116:119]
    ds_read_b128 v[236:239], v93 offset:0
    s_waitcnt lgkmcnt(10)
    v_mfma_f32_16x16x32_bf16 v[120:123], v[200:203], v[224:227], v[120:123]
    ds_read_b64_tr_b16 v[220:221], v255 offset:0
    v_mfma_f32_16x16x32_bf16 v[128:131], v[200:203], v[228:231], v[128:131]
    ds_read_b64_tr_b16 v[222:223], v255 offset:1024
    v_add_u32 v255, s51, v255
    v_mfma_f32_16x16x32_bf16 v[136:139], v[200:203], v[232:235], v[136:139]
    ds_read_b128 v[240:243], v93 offset:2048
    s_add_u32 s49, s49, 1
    s_cmp_eq_u32 s49, 7
    s_cselect_b32 s51, 0xffff4000, s48
    s_cselect_b32 s49, 0, s49
    s_waitcnt lgkmcnt(10)
    v_mfma_f32_16x16x32_bf16 v[124:127], v[204:207], v[224:227], v[124:127]
    ds_read_b64_tr_b16 v[192:193], v248 offset:0
    v_mfma_f32_16x16x32_bf16 v[132:135], v[204:207], v[228:231], v[132:135]
    ds_read_b64_tr_b16 v[194:195], v248 offset:1024
    v_add_u32 v248, s51, v248
    v_mfma_f32_16x16x32_bf16 v[140:143], v[204:207], v[232:235], v[140:143]
    ds_read_b128 v[244:247], v93 offset:4096
    v_add_u32 v93, s52, v93
    s_waitcnt lgkmcnt(11)
    v_mfma_f32_16x16x32_bf16 v[144:147], v[208:211], v[224:227], v[144:147]
    ds_read_b64_tr_b16 v[196:197], v249 offset:0
    v_mfma_f32_16x16x32_bf16 v[152:155], v[208:211], v[228:231], v[152:155]
    ds_read_b64_tr_b16 v[198:199], v249 offset:1024
    v_add_u32 v249, s51, v249
    v_mfma_f32_16x16x32_bf16 v[160:163], v[208:211], v[232:235], v[160:163]
    s_waitcnt lgkmcnt(11)
    v_mfma_f32_16x16x32_bf16 v[148:151], v[212:215], v[224:227], v[148:151]
    ds_read_b64_tr_b16 v[200:201], v250 offset:0
    v_mfma_f32_16x16x32_bf16 v[156:159], v[212:215], v[228:231], v[156:159]
    ds_read_b64_tr_b16 v[202:203], v250 offset:1024
    v_add_u32 v250, s51, v250
    v_mfma_f32_16x16x32_bf16 v[164:167], v[212:215], v[232:235], v[164:167]
    s_waitcnt lgkmcnt(11)
    v_mfma_f32_16x16x32_bf16 v[168:171], v[216:219], v[224:227], v[168:171]
    ds_read_b64_tr_b16 v[204:205], v251 offset:0
    v_mfma_f32_16x16x32_bf16 v[176:179], v[216:219], v[228:231], v[176:179]
    ds_read_b64_tr_b16 v[206:207], v251 offset:1024
    v_add_u32 v251, s51, v251
    v_mfma_f32_16x16x32_bf16 v[184:187], v[216:219], v[232:235], v[184:187]
    s_waitcnt lgkmcnt(10)
    v_mfma_f32_16x16x32_bf16 v[172:175], v[220:223], v[224:227], v[172:175]
    ds_read_b64_tr_b16 v[208:209], v252 offset:0
    v_mfma_f32_16x16x32_bf16 v[180:183], v[220:223], v[228:231], v[180:183]
    ds_read_b64_tr_b16 v[210:211], v252 offset:1024
    v_add_u32 v252, s51, v252
    v_mfma_f32_16x16x32_bf16 v[188:191], v[220:223], v[232:235], v[188:191]
    s_waitcnt lgkmcnt(8)
    v_mfma_f32_16x16x32_bf16 v[96:99], v[192:195], v[236:239], v[96:99]
    ds_read_b64_tr_b16 v[212:213], v253 offset:0
    v_mfma_f32_16x16x32_bf16 v[104:107], v[192:195], v[240:243], v[104:107]
    ds_read_b64_tr_b16 v[214:215], v253 offset:1024
    v_add_u32 v253, s51, v253
    v_mfma_f32_16x16x32_bf16 v[112:115], v[192:195], v[244:247], v[112:115]
    s_waitcnt lgkmcnt(8)
    v_mfma_f32_16x16x32_bf16 v[100:103], v[196:199], v[236:239], v[100:103]
    ds_read_b64_tr_b16 v[216:217], v254 offset:0
    v_mfma_f32_16x16x32_bf16 v[108:111], v[196:199], v[240:243], v[108:111]
    ds_read_b64_tr_b16 v[218:219], v254 offset:1024
    v_add_u32 v254, s51, v254
    v_mfma_f32_16x16x32_bf16 v[116:119], v[196:199], v[244:247], v[116:119]
    s_sub_u32 s47, s47, 1
    s_waitcnt lgkmcnt(8)
    v_mfma_f32_16x16x32_bf16 v[120:123], v[200:203], v[236:239], v[120:123]
    ds_read_b64_tr_b16 v[220:221], v255 offset:0
    v_mfma_f32_16x16x32_bf16 v[128:131], v[200:203], v[240:243], v[128:131]
    ds_read_b64_tr_b16 v[222:223], v255 offset:1024
    v_add_u32 v255, s51, v255
    v_mfma_f32_16x16x32_bf16 v[136:139], v[200:203], v[244:247], v[136:139]
    s_cmp_lg_u32 s47, 0
    s_cbranch_scc1 L_p1
    v_xor_b32 v224, 131072, v94
    v_xor_b32 v225, 131136, v94
    v_xor_b32 v226, 131200, v94
    v_xor_b32 v227, 131264, v94
    s_waitcnt vmcnt(0)
    s_barrier
    ds_read_b128 v[192:195], v224 offset:0
    ds_read_b128 v[196:199], v225 offset:0
    ds_read_b128 v[200:203], v226 offset:0
    s_waitcnt lgkmcnt(11)
    v_mfma_f32_16x16x32_bf16 v[124:127], v[204:207], v[236:239], v[124:127]
    v_mul_f32 v96, s58, v96
    v_mul_f32 v97, s58, v97
    v_mfma_f32_16x16x32_bf16 v[132:135], v[204:207], v[240:243], v[132:135]
    v_mul_f32 v98, s58, v98
    v_mul_f32 v99, s58, v99
    v_mfma_f32_16x16x32_bf16 v[140:143], v[204:207], v[244:247], v[140:143]
    v_mul_f32 v100, s58, v100
    v_mul_f32 v101, s58, v101
    ds_read_b128 v[204:207], v227 offset:0
    s_waitcnt lgkmcnt(10)
    v_mfma_f32_16x16x32_bf16 v[144:147], v[208:211], v[236:239], v[144:147]
    v_mul_f32 v102, s58, v102
    v_mul_f32 v103, s58, v103
    v_mfma_f32_16x16x32_bf16 v[152:155], v[208:211], v[240:243], v[152:155]
    v_cvt_pk_bf16_f32 v96, v96, v97
    v_cvt_pk_bf16_f32 v97, v98, v99
    v_mfma_f32_16x16x32_bf16 v[160:163], v[208:211], v[244:247], v[160:163]
    v_cvt_pk_bf16_f32 v100, v100, v101
    v_cvt_pk_bf16_f32 v101, v102, v103
    ds_read_b128 v[208:211], v224 offset:1024
    s_waitcnt lgkmcnt(9)
    v_mfma_f32_16x16x32_bf16 v[148:151], v[212:215], v[236:239], v[148:151]
    v_cndmask_b32 v98, v100, v96, s[68:69]
    v_cndmask_b32 v99, v101, v97, s[68:69]
    v_mfma_f32_16x16x32_bf16 v[156:159], v[212:215], v[240:243], v[156:159]
    v_cndmask_b32 v96, v96, v100, s[68:69]
    v_cndmask_b32 v97, v97, v101, s[68:69]
    v_mfma_f32_16x16x32_bf16 v[164:167], v[212:215], v[244:247], v[164:167]
    v_mul_f32 v104, s58, v104
    v_mul_f32 v105, s58, v105
    ds_read_b128 v[212:215], v225 offset:1024
    s_waitcnt lgkmcnt(8)
    v_mfma_f32_16x16x32_bf16 v[168:171], v[216:219], v[236:239], v[168:171]
    v_mul_f32 v106, s58, v106
    v_mul_f32 v107, s58, v107
    v_mfma_f32_16x16x32_bf16 v[176:179], v[216:219], v[240:243], v[176:179]
    v_mul_f32 v108, s58, v108
    v_mul_f32 v109, s58, v109
    v_mfma_f32_16x16x32_bf16 v[184:187], v[216:219], v[244:247], v[184:187]
    v_mul_f32 v110, s58, v110
    v_mul_f32 v111, s58, v111
    ds_read_b128 v[216:219], v226 offset:1024
    s_waitcnt lgkmcnt(7)
    v_mfma_f32_16x16x32_bf16 v[172:175], v[220:223], v[236:239], v[172:175]
    v_cvt_pk_bf16_f32 v104, v104, v105
    v_cvt_pk_bf16_f32 v105, v106, v107
    v_mfma_f32_16x16x32_bf16 v[180:183], v[220:223], v[240:243], v[180:183]
    v_cvt_pk_bf16_f32 v108, v108, v109
    v_cvt_pk_bf16_f32 v109, v110, v111
    v_mfma_f32_16x16x32_bf16 v[188:191], v[220:223], v[244:247], v[188:191]
    v_cndmask_b32 v106, v108, v104, s[68:69]
    v_cndmask_b32 v107, v109, v105, s[68:69]
    ds_read_b128 v[220:223], v227 offset:1024
    s_waitcnt lgkmcnt(7)
    v_mfma_f32_16x16x32_bf16 v[100:103], v[192:195], v[96:99], 0
    v_cndmask_b32 v104, v104, v108, s[68:69]
    v_cndmask_b32 v105, v105, v109, s[68:69]
    v_mul_f32 v112, s58, v112
    v_mul_f32 v113, s58, v113
    v_mfma_f32_16x16x32_bf16 v[108:111], v[192:195], v[104:107], 0
    v_mul_f32 v114, s58, v114
    v_mul_f32 v115, s58, v115
    v_mul_f32 v116, s58, v116
    v_mul_f32 v117, s58, v117
    v_mul_f32 v118, s58, v118
    v_mul_f32 v119, s58, v119
    v_cvt_pk_bf16_f32 v112, v112, v113
    v_cvt_pk_bf16_f32 v113, v114, v115
    v_cvt_pk_bf16_f32 v116, v116, v117
    v_cvt_pk_bf16_f32 v117, v118, v119
    v_cndmask_b32 v114, v116, v112, s[68:69]
    v_cndmask_b32 v115, v117, v113, s[68:69]
    v_cndmask_b32 v112, v112, v116, s[68:69]
    v_cndmask_b32 v113, v113, v117, s[68:69]
    v_xor_b32 v248, 147456, v95
    v_xor_b32 v249, 147488, v95
    v_xor_b32 v250, 147520, v95
    v_xor_b32 v251, 147552, v95
    v_xor_b32 v252, 147584, v95
    v_xor_b32 v253, 147616, v95
    v_xor_b32 v254, 147648, v95
    v_xor_b32 v255, 147680, v95
    v_pk_mov_b32 v[0:1], 0, 0
    v_pk_mov_b32 v[2:3], 0, 0
    v_pk_mov_b32 v[4:5], 0, 0
    v_pk_mov_b32 v[92:93], 0, 0
    v_pk_mov_b32 v[94:95], 0, 0
    v_mov_b32 v228, 0xff800000
    v_mov_b32 v229, 0xff800000
    v_mov_b32 v230, 0xff800000
    v_mul_f32 v120, s58, v120
    v_mul_f32 v121, s58, v121
    v_mfma_f32_16x16x32_bf16 v[116:119], v[192:195], v[112:115], 0
    v_mul_f32 v122, s58, v122
    v_mul_f32 v123, s58, v123
    v_mul_f32 v124, s58, v124
    v_mul_f32 v125, s58, v125
    v_mul_f32 v126, s58, v126
    v_mul_f32 v127, s58, v127
    v_cvt_pk_bf16_f32 v120, v120, v121
    v_cvt_pk_bf16_f32 v121, v122, v123
    v_cvt_pk_bf16_f32 v124, v124, v125
    v_cvt_pk_bf16_f32 v125, v126, v127
    v_cndmask_b32 v122, v124, v120, s[68:69]
    v_cndmask_b32 v123, v125, v121, s[68:69]
    v_cndmask_b32 v120, v120, v124, s[68:69]
    v_cndmask_b32 v121, v121, v125, s[68:69]
    v_mul_f32 v128, s58, v128
    v_mul_f32 v129, s58, v129
    s_waitcnt lgkmcnt(6)
    v_mfma_f32_16x16x32_bf16 v[100:103], v[196:199], v[120:123], v[100:103]
    v_mul_f32 v130, s58, v130
    v_mul_f32 v131, s58, v131
    v_mul_f32 v132, s58, v132
    v_mul_f32 v133, s58, v133
    v_mul_f32 v134, s58, v134
    v_mul_f32 v135, s58, v135
    v_cvt_pk_bf16_f32 v128, v128, v129
    v_cvt_pk_bf16_f32 v129, v130, v131
    v_cvt_pk_bf16_f32 v132, v132, v133
    v_cvt_pk_bf16_f32 v133, v134, v135
    v_cndmask_b32 v130, v132, v128, s[68:69]
    v_cndmask_b32 v131, v133, v129, s[68:69]
    v_cndmask_b32 v128, v128, v132, s[68:69]
    v_cndmask_b32 v129, v129, v133, s[68:69]
    v_mul_f32 v136, s58, v136
    v_mul_f32 v137, s58, v137
    v_mfma_f32_16x16x32_bf16 v[108:111], v[196:199], v[128:131], v[108:111]
    v_mul_f32 v138, s58, v138
    v_mul_f32 v139, s58, v139
    v_mul_f32 v140, s58, v140
    v_mul_f32 v141, s58, v141
    v_mul_f32 v142, s58, v142
    v_mul_f32 v143, s58, v143
    v_cvt_pk_bf16_f32 v136, v136, v137
    v_cvt_pk_bf16_f32 v137, v138, v139
    v_cvt_pk_bf16_f32 v140, v140, v141
    v_cvt_pk_bf16_f32 v141, v142, v143
    v_cndmask_b32 v138, v140, v136, s[68:69]
    v_cndmask_b32 v139, v141, v137, s[68:69]
    v_cndmask_b32 v136, v136, v140, s[68:69]
    v_cndmask_b32 v137, v137, v141, s[68:69]
    v_mul_f32 v144, s58, v144
    v_mul_f32 v145, s58, v145
    v_mfma_f32_16x16x32_bf16 v[116:119], v[196:199], v[136:139], v[116:119]
    v_mul_f32 v146, s58, v146
    v_mul_f32 v147, s58, v147
    v_mul_f32 v148, s58, v148
    v_mul_f32 v149, s58, v149
    v_mul_f32 v150, s58, v150
    v_mul_f32 v151, s58, v151
    v_cvt_pk_bf16_f32 v144, v144, v145
    v_cvt_pk_bf16_f32 v145, v146, v147
    v_cvt_pk_bf16_f32 v148, v148, v149
    v_cvt_pk_bf16_f32 v149, v150, v151
    v_cndmask_b32 v146, v148, v144, s[68:69]
    v_cndmask_b32 v147, v149, v145, s[68:69]
    v_cndmask_b32 v144, v144, v148, s[68:69]
    v_cndmask_b32 v145, v145, v149, s[68:69]
    v_mul_f32 v152, s58, v152
    v_mul_f32 v153, s58, v153
    s_waitcnt lgkmcnt(5)
    v_mfma_f32_16x16x32_bf16 v[100:103], v[200:203], v[144:147], v[100:103]
    v_mul_f32 v154, s58, v154
    v_mul_f32 v155, s58, v155
    v_mul_f32 v156, s58, v156
    v_mul_f32 v157, s58, v157
    v_mul_f32 v158, s58, v158
    v_mul_f32 v159, s58, v159
    v_cvt_pk_bf16_f32 v152, v152, v153
    v_cvt_pk_bf16_f32 v153, v154, v155
    v_cvt_pk_bf16_f32 v156, v156, v157
    v_cvt_pk_bf16_f32 v157, v158, v159
    v_cndmask_b32 v154, v156, v152, s[68:69]
    v_cndmask_b32 v155, v157, v153, s[68:69]
    v_cndmask_b32 v152, v152, v156, s[68:69]
    v_cndmask_b32 v153, v153, v157, s[68:69]
    v_mul_f32 v160, s58, v160
    v_mul_f32 v161, s58, v161
    v_mfma_f32_16x16x32_bf16 v[108:111], v[200:203], v[152:155], v[108:111]
    v_mul_f32 v162, s58, v162
    v_mul_f32 v163, s58, v163
    v_mul_f32 v164, s58, v164
    v_mul_f32 v165, s58, v165
    v_mul_f32 v166, s58, v166
    v_mul_f32 v167, s58, v167
    v_cvt_pk_bf16_f32 v160, v160, v161
    v_cvt_pk_bf16_f32 v161, v162, v163
    v_cvt_pk_bf16_f32 v164, v164, v165
    v_cvt_pk_bf16_f32 v165, v166, v167
    v_cndmask_b32 v162, v164, v160, s[68:69]
    v_cndmask_b32 v163, v165, v161, s[68:69]
    v_cndmask_b32 v160, v160, v164, s[68:69]
    v_cndmask_b32 v161, v161, v165, s[68:69]
    v_mul_f32 v168, s58, v168
    v_mul_f32 v169, s58, v169
    v_mfma_f32_16x16x32_bf16 v[116:119], v[200:203], v[160:163], v[116:119]
    v_mul_f32 v170, s58, v170
    v_mul_f32 v171, s58, v171
    v_mul_f32 v172, s58, v172
    v_mul_f32 v173, s58, v173
    v_mul_f32 v174, s58, v174
    v_mul_f32 v175, s58, v175
    v_cvt_pk_bf16_f32 v168, v168, v169
    v_cvt_pk_bf16_f32 v169, v170, v171
    v_cvt_pk_bf16_f32 v172, v172, v173
    v_cvt_pk_bf16_f32 v173, v174, v175
    v_cndmask_b32 v170, v172, v168, s[68:69]
    v_cndmask_b32 v171, v173, v169, s[68:69]
    v_cndmask_b32 v168, v168, v172, s[68:69]
    v_cndmask_b32 v169, v169, v173, s[68:69]
    v_mul_f32 v176, s58, v176
    v_mul_f32 v177, s58, v177
    s_waitcnt lgkmcnt(4)
    v_mfma_f32_16x16x32_bf16 v[100:103], v[204:207], v[168:171], v[100:103]
    v_mul_f32 v178, s58, v178
    v_mul_f32 v179, s58, v179
    v_mul_f32 v180, s58, v180
    v_mul_f32 v181, s58, v181
    v_mul_f32 v182, s58, v182
    v_mul_f32 v183, s58, v183
    v_cvt_pk_bf16_f32 v176, v176, v177
    v_cvt_pk_bf16_f32 v177, v178, v179
    v_cvt_pk_bf16_f32 v180, v180, v181
    v_cvt_pk_bf16_f32 v181, v182, v183
    v_cndmask_b32 v178, v180, v176, s[68:69]
    v_cndmask_b32 v179, v181, v177, s[68:69]
    v_cndmask_b32 v176, v176, v180, s[68:69]
    v_cndmask_b32 v177, v177, v181, s[68:69]
    v_mul_f32 v184, s58, v184
    v_mul_f32 v185, s58, v185
    v_mfma_f32_16x16x32_bf16 v[108:111], v[204:207], v[176:179], v[108:111]
    v_mul_f32 v186, s58, v186
    v_mul_f32 v187, s58, v187
    v_mul_f32 v188, s58, v188
    v_mul_f32 v189, s58, v189
    v_mul_f32 v190, s58, v190
    v_mul_f32 v191, s58, v191
    v_cvt_pk_bf16_f32 v184, v184, v185
    v_cvt_pk_bf16_f32 v185, v186, v187
    v_cvt_pk_bf16_f32 v188, v188, v189
    v_cvt_pk_bf16_f32 v189, v190, v191
    v_cndmask_b32 v186, v188, v184, s[68:69]
    v_cndmask_b32 v187, v189, v185, s[68:69]
    v_cndmask_b32 v184, v184, v188, s[68:69]
    v_cndmask_b32 v185, v185, v189, s[68:69]
    s_nop 1
    v_mfma_f32_16x16x32_bf16 v[116:119], v[204:207], v[184:187], v[116:119]
L_reenter:
    s_waitcnt lgkmcnt(3)
    v_mfma_f32_16x16x32_bf16 v[124:127], v[208:211], v[96:99], 0
    ds_read_b128 v[192:195], v224 offset:8192
    v_mfma_f32_16x16x32_bf16 v[132:135], v[208:211], v[104:107], 0
    ds_read_b128 v[196:199], v225 offset:8192
    v_mfma_f32_16x16x32_bf16 v[140:143], v[208:211], v[112:115], 0
    ds_read_b128 v[200:203], v226 offset:8192
    s_waitcnt lgkmcnt(5)
    v_mfma_f32_16x16x32_bf16 v[124:127], v[212:215], v[120:123], v[124:127]
    ds_read_b128 v[204:207], v227 offset:8192
    v_max3_f32 v228, v228, v100, v101
    v_max3_f32 v229, v229, v108, v109
    v_max3_f32 v230, v230, v116, v117
    v_mfma_f32_16x16x32_bf16 v[132:135], v[212:215], v[128:131], v[132:135]
    v_max3_f32 v228, v228, v102, v103
    v_max3_f32 v229, v229, v110, v111
    v_max3_f32 v230, v230, v118, v119
    v_mfma_f32_16x16x32_bf16 v[140:143], v[212:215], v[136:139], v[140:143]
    v_mov_b32 v231, v228
    v_mov_b32 v232, v229
    v_mov_b32 v233, v230
    s_waitcnt lgkmcnt(5)
    v_mfma_f32_16x16x32_bf16 v[124:127], v[216:219], v[144:147], v[124:127]
    s_nop 1
    v_permlane16_swap_b32 v228, v231
    v_permlane16_swap_b32 v229, v232
    v_mfma_f32_16x16x32_bf16 v[132:135], v[216:219], v[152:155], v[132:135]
    v_permlane16_swap_b32 v230, v233
    s_nop 0
    v_max_f32 v228, v228, v231
    v_mfma_f32_16x16x32_bf16 v[140:143], v[216:219], v[160:163], v[140:143]
    v_max_f32 v229, v229, v232
    v_max_f32 v230, v230, v233
    v_mov_b32 v231, v228
    s_waitcnt lgkmcnt(4)
    v_mfma_f32_16x16x32_bf16 v[124:127], v[220:223], v[168:171], v[124:127]
    v_mov_b32 v232, v229
    v_mov_b32 v233, v230
    s_nop 1
    v_mfma_f32_16x16x32_bf16 v[132:135], v[220:223], v[176:179], v[132:135]
    v_permlane32_swap_b32 v228, v231
    v_permlane32_swap_b32 v229, v232
    v_permlane32_swap_b32 v230, v233
    v_mfma_f32_16x16x32_bf16 v[140:143], v[220:223], v[184:187], v[140:143]
    s_nop 0
    v_max_f32 v228, v228, v231
    v_max_f32 v229, v229, v232
    ds_read_b128 v[208:211], v224 offset:9216
    ds_read_b128 v[212:215], v225 offset:9216
    ds_read_b128 v[216:219], v226 offset:9216
    v_max_f32 v230, v230, v233
    v_sub_f32 v100, v100, v228
    v_sub_f32 v108, v108, v229
    v_sub_f32 v116, v116, v230
    v_sub_f32 v101, v101, v228
    v_sub_f32 v109, v109, v229
    v_sub_f32 v117, v117, v230
    v_sub_f32 v102, v102, v228
    v_sub_f32 v110, v110, v229
    v_sub_f32 v118, v118, v230
    v_sub_f32 v103, v103, v228
    v_sub_f32 v111, v111, v229
    v_sub_f32 v119, v119, v230
    v_sub_f32 v236, 0, v228
    v_sub_f32 v240, 0, v229
    v_sub_f32 v244, 0, v230
    v_sub_f32 v237, 0, v228
    v_sub_f32 v241, 0, v229
    v_sub_f32 v245, 0, v230
    v_sub_f32 v238, 0, v228
    v_sub_f32 v242, 0, v229
    v_sub_f32 v246, 0, v230
    v_sub_f32 v239, 0, v228
    v_sub_f32 v243, 0, v229
    v_sub_f32 v247, 0, v230
    v_mov_b32 v228, 0
    v_mov_b32 v229, 0
    v_mov_b32 v230, 0
    v_exp_f32 v100, v100
    v_add_f32 v124, v236, v124
    v_add_f32 v228, v228, v100
    v_exp_f32 v101, v101
    v_add_f32 v125, v236, v125
    v_add_f32 v228, v228, v101
    v_cvt_pk_bf16_f32 v148, v100, v101
    v_exp_f32 v102, v102
    v_add_f32 v126, v236, v126
    v_add_f32 v228, v228, v102
    v_exp_f32 v103, v103
    v_add_f32 v127, v236, v127
    v_add_f32 v228, v228, v103
    v_cvt_pk_bf16_f32 v149, v102, v103
    v_exp_f32 v108, v108
    v_add_f32 v132, v240, v132
    v_add_f32 v229, v229, v108
    v_exp_f32 v109, v109
    v_add_f32 v133, v240, v133
    v_add_f32 v229, v229, v109
    v_cvt_pk_bf16_f32 v156, v108, v109
    v_exp_f32 v110, v110
    v_add_f32 v134, v240, v134
    v_add_f32 v229, v229, v110
    v_exp_f32 v111, v111
    v_add_f32 v135, v240, v135
    v_add_f32 v229, v229, v111
    v_cvt_pk_bf16_f32 v157, v110, v111
    v_exp_f32 v116, v116
    v_add_f32 v140, v244, v140
    v_add_f32 v230, v230, v116
    v_exp_f32 v117, v117
    v_add_f32 v141, v244, v141
    v_add_f32 v230, v230, v117
    v_cvt_pk_bf16_f32 v164, v116, v117
    v_exp_f32 v118, v118
    v_add_f32 v142, v244, v142
    v_add_f32 v230, v230, v118
    v_exp_f32 v119, v119
    v_add_f32 v143, v244, v143
    v_add_f32 v230, v230, v119
    v_cvt_pk_bf16_f32 v165, v118, v119
    v_exp_f32 v124, v124
    s_nop 0
    v_add_f32 v228, v228, v124
    v_exp_f32 v125, v125
    s_nop 0
    v_add_f32 v228, v228, v125
    v_cvt_pk_bf16_f32 v150, v124, v125
    v_exp_f32 v126, v126
    s_nop 0
    v_add_f32 v228, v228, v126
    v_exp_f32 v127, v127
    s_nop 0
    v_add_f32 v228, v228, v127
    v_cvt_pk_bf16_f32 v151, v126, v127
    v_exp_f32 v132, v132
    s_nop 0
    v_add_f32 v229, v229, v132
    v_exp_f32 v133, v133
    s_nop 0
    s_mov_b32 s55, 0x218b218
    s_mov_b32 s56, 0x67cd67c
    s_mov_b32 s47, 8
    s_waitcnt lgkmcnt(5)
L_p2:
    v_mfma_f32_16x16x32_bf16 v[100:103], v[192:195], v[96:99], v[236:239]
    ds_read_b128 v[220:223], v227 offset:9216
    v_add_f32 v229, v229, v133
    v_cvt_pk_bf16_f32 v158, v132, v133
    v_mfma_f32_16x16x32_bf16 v[108:111], v[192:195], v[104:107], v[240:243]
    s_barrier
    v_exp_f32 v134, v134
    v_mfma_f32_16x16x32_bf16 v[116:119], v[192:195], v[112:115], v[244:247]
    ds_read_b64_tr_b16 v[192:193], v248 offset:0
    v_add_f32 v229, v229, v134
    v_mfma_f32_16x16x32_bf16 v[100:103], v[196:199], v[120:123], v[100:103]
    s_and_b32 s53, s55, 15
    v_exp_f32 v135, v135
    v_mfma_f32_16x16x32_bf16 v[108:111], v[196:199], v[128:131], v[108:111]
    ds_read_b64_tr_b16 v[194:195], v248 offset:1024
    v_add_f32 v229, v229, v135
    v_cvt_pk_bf16_f32 v159, v134, v135
    v_mfma_f32_16x16x32_bf16 v[116:119], v[196:199], v[136:139], v[116:119]
    s_waitcnt lgkmcnt(6)
    v_exp_f32 v140, v140
    v_mfma_f32_16x16x32_bf16 v[100:103], v[200:203], v[144:147], v[100:103]
    ds_read_b64_tr_b16 v[196:197], v249 offset:0
    v_add_f32 v230, v230, v140
    v_mfma_f32_16x16x32_bf16 v[108:111], v[200:203], v[152:155], v[108:111]
    s_lshl_b32 s53, s53, 14
    v_exp_f32 v141, v141
    v_mfma_f32_16x16x32_bf16 v[116:119], v[200:203], v[160:163], v[116:119]
    ds_read_b64_tr_b16 v[198:199], v249 offset:1024
    v_add_f32 v230, v230, v141
    v_cvt_pk_bf16_f32 v166, v140, v141
    v_mfma_f32_16x16x32_bf16 v[100:103], v[204:207], v[168:171], v[100:103]
    s_lshr_b32 s55, s55, 4
    v_exp_f32 v142, v142
    v_mfma_f32_16x16x32_bf16 v[108:111], v[204:207], v[176:179], v[108:111]
    ds_read_b64_tr_b16 v[200:201], v250 offset:0
    v_add_f32 v230, v230, v142
    v_xor_b32 v224, s53, v224
    v_mfma_f32_16x16x32_bf16 v[116:119], v[204:207], v[184:187], v[116:119]
    s_waitcnt lgkmcnt(7)
    v_exp_f32 v143, v143
    v_mfma_f32_16x16x32_bf16 v[124:127], v[208:211], v[96:99], v[236:239]
    ds_read_b64_tr_b16 v[202:203], v250 offset:1024
    v_add_f32 v230, v230, v143
    v_cvt_pk_bf16_f32 v167, v142, v143
    v_mfma_f32_16x16x32_bf16 v[132:135], v[208:211], v[104:107], v[240:243]
    s_and_b32 s54, s56, 15
    v_exp_f32 v100, v100
    v_mfma_f32_16x16x32_bf16 v[140:143], v[208:211], v[112:115], v[244:247]
    ds_read_b64_tr_b16 v[204:205], v251 offset:0
    v_add_f32 v228, v228, v100
    v_xor_b32 v225, s53, v225
    v_mfma_f32_16x16x32_bf16 v[124:127], v[212:215], v[120:123], v[124:127]
    s_lshl_b32 s54, s54, 14
    v_exp_f32 v101, v101
    v_mfma_f32_16x16x32_bf16 v[132:135], v[212:215], v[128:131], v[132:135]
    ds_read_b64_tr_b16 v[206:207], v251 offset:1024
    v_add_f32 v228, v228, v101
    v_cvt_pk_bf16_f32 v172, v100, v101
    v_mfma_f32_16x16x32_bf16 v[140:143], v[212:215], v[136:139], v[140:143]
    s_waitcnt lgkmcnt(8)
    v_exp_f32 v102, v102
    v_mfma_f32_16x16x32_bf16 v[124:127], v[216:219], v[144:147], v[124:127]
    ds_read_b64_tr_b16 v[208:209], v252 offset:0
    v_add_f32 v228, v228, v102
    v_xor_b32 v226, s53, v226
    v_mfma_f32_16x16x32_bf16 v[132:135], v[216:219], v[152:155], v[132:135]
    s_lshr_b32 s56, s56, 4
    v_exp_f32 v103, v103
    v_mfma_f32_16x16x32_bf16 v[140:143], v[216:219], v[160:163], v[140:143]
    ds_read_b64_tr_b16 v[210:211], v252 offset:1024
    v_add_f32 v228, v228, v103
    v_cvt_pk_bf16_f32 v173, v102, v103
    v_mfma_f32_16x16x32_bf16 v[124:127], v[220:223], v[168:171], v[124:127]
    v_exp_f32 v108, v108
    v_mfma_f32_16x16x32_bf16 v[132:135], v[220:223], v[176:179], v[132:135]
    ds_read_b64_tr_b16 v[212:213], v253 offset:0
    v_add_f32 v229, v229, v108
    v_xor_b32 v227, s53, v227
    v_mfma_f32_16x16x32_bf16 v[140:143], v[220:223], v[184:187], v[140:143]
    s_waitcnt lgkmcnt(7)
    v_exp_f32 v109, v109
    v_mfma_f32_16x16x32_bf16 v[0:3], v[192:195], v[148:151], v[0:3]
    ds_read_b64_tr_b16 v[214:215], v253 offset:1024
    v_add_f32 v229, v229, v109
    v_cvt_pk_bf16_f32 v180, v108, v109
    v_mfma_f32_16x16x32_bf16 v[32:35], v[192:195], v[156:159], v[32:35]
    v_exp_f32 v110, v110
    v_mfma_f32_16x16x32_bf16 v[64:67], v[192:195], v[164:167], v[64:67]
    ds_read_b64_tr_b16 v[216:217], v254 offset:0
    v_add_f32 v229, v229, v110
    v_mfma_f32_16x16x32_bf16 v[4:7], v[196:199], v[148:151], v[4:7]
    v_exp_f32 v111, v111
    v_mfma_f32_16x16x32_bf16 v[36:39], v[196:199], v[156:159], v[36:39]
    ds_read_b64_tr_b16 v[218:219], v254 offset:1024
    v_add_f32 v229, v229, v111
    v_cvt_pk_bf16_f32 v181, v110, v111
    v_mfma_f32_16x16x32_bf16 v[68:71], v[196:199], v[164:167], v[68:71]
    s_waitcnt lgkmcnt(6)
    v_exp_f32 v116, v116
    v_mfma_f32_16x16x32_bf16 v[8:11], v[200:203], v[148:151], v[8:11]
    ds_read_b64_tr_b16 v[220:221], v255 offset:0
    v_add_f32 v230, v230, v116
    v_mfma_f32_16x16x32_bf16 v[40:43], v[200:203], v[156:159], v[40:43]
    v_exp_f32 v117, v117
    v_mfma_f32_16x16x32_bf16 v[72:75], v[200:203], v[164:167], v[72:75]
    ds_read_b64_tr_b16 v[222:223], v255 offset:1024
    v_add_f32 v230, v230, v117
    v_cvt_pk_bf16_f32 v188, v116, v117
    v_mfma_f32_16x16x32_bf16 v[12:15], v[204:207], v[148:151], v[12:15]
    v_exp_f32 v118, v118
    v_mfma_f32_16x16x32_bf16 v[44:47], v[204:207], v[156:159], v[44:47]
    ds_read_b128 v[192:195], v224 offset:0
    v_add_f32 v230, v230, v118
    v_mfma_f32_16x16x32_bf16 v[76:79], v[204:207], v[164:167], v[76:79]
    s_waitcnt lgkmcnt(5)
    v_exp_f32 v119, v119
    v_mfma_f32_16x16x32_bf16 v[16:19], v[208:211], v[148:151], v[16:19]
    ds_read_b128 v[196:199], v225 offset:0
    v_add_f32 v230, v230, v119
    v_cvt_pk_bf16_f32 v189, v118, v119
    v_mfma_f32_16x16x32_bf16 v[48:51], v[208:211], v[156:159], v[48:51]
    v_exp_f32 v124, v124
    v_mfma_f32_16x16x32_bf16 v[80:83], v[208:211], v[164:167], v[80:83]
    ds_read_b128 v[200:203], v226 offset:0
    v_add_f32 v228, v228, v124
    v_mfma_f32_16x16x32_bf16 v[20:23], v[212:215], v[148:151], v[20:23]
    v_exp_f32 v125, v125
    v_mfma_f32_16x16x32_bf16 v[52:55], v[212:215], v[156:159], v[52:55]
    ds_read_b128 v[204:207], v227 offset:0
    v_add_f32 v228, v228, v125
    v_cvt_pk_bf16_f32 v174, v124, v125
    v_mfma_f32_16x16x32_bf16 v[84:87], v[212:215], v[164:167], v[84:87]
    s_waitcnt lgkmcnt(4)
    v_exp_f32 v126, v126
    v_mfma_f32_16x16x32_bf16 v[24:27], v[216:219], v[148:151], v[24:27]
    ds_read_b128 v[208:211], v224 offset:1024
    v_add_f32 v228, v228, v126
    v_mfma_f32_16x16x32_bf16 v[56:59], v[216:219], v[156:159], v[56:59]
    s_sub_u32 s47, s47, 1
    v_exp_f32 v127, v127
    v_mfma_f32_16x16x32_bf16 v[88:91], v[216:219], v[164:167], v[88:91]
    ds_read_b128 v[212:215], v225 offset:1024
    v_add_f32 v228, v228, v127
    v_cvt_pk_bf16_f32 v175, v126, v127
    v_mfma_f32_16x16x32_bf16 v[28:31], v[220:223], v[148:151], v[28:31]
    s_cmp_eq_u32 s47, 0
    v_exp_f32 v132, v132
    v_mfma_f32_16x16x32_bf16 v[60:63], v[220:223], v[156:159], v[60:63]
    ds_read_b128 v[216:219], v226 offset:1024
    v_add_f32 v229, v229, v132
    v_mfma_f32_16x16x32_bf16 v[92:95], v[220:223], v[164:167], v[92:95]
    s_waitcnt lgkmcnt(5)
    v_exp_f32 v133, v133
    s_cbranch_scc1 L_tail
    v_mfma_f32_16x16x32_bf16 v[100:103], v[192:195], v[96:99], v[236:239]
    ds_read_b128 v[220:223], v227 offset:1024
    v_add_f32 v229, v229, v133
    v_cvt_pk_bf16_f32 v182, v132, v133
    v_mfma_f32_16x16x32_bf16 v[108:111], v[192:195], v[104:107], v[240:243]
    v_exp_f32 v134, v134
    v_mfma_f32_16x16x32_bf16 v[116:119], v[192:195], v[112:115], v[244:247]
    ds_read_b64_tr_b16 v[192:193], v248 offset:8192
    v_add_f32 v229, v229, v134
    v_mfma_f32_16x16x32_bf16 v[100:103], v[196:199], v[120:123], v[100:103]
    v_exp_f32 v135, v135
    v_mfma_f32_16x16x32_bf16 v[108:111], v[196:199], v[128:131], v[108:111]
    ds_read_b64_tr_b16 v[194:195], v248 offset:9216
    v_add_f32 v229, v229, v135
    v_cvt_pk_bf16_f32 v183, v134, v135
    v_mfma_f32_16x16x32_bf16 v[116:119], v[196:199], v[136:139], v[116:119]
    s_waitcnt lgkmcnt(6)
    v_exp_f32 v140, v140
    v_mfma_f32_16x16x32_bf16 v[100:103], v[200:203], v[144:147], v[100:103]
    ds_read_b64_tr_b16 v[196:197], v249 offset:8192
    v_add_f32 v230, v230, v140
    v_mfma_f32_16x16x32_bf16 v[108:111], v[200:203], v[152:155], v[108:111]
    v_exp_f32 v141, v141
    v_mfma_f32_16x16x32_bf16 v[116:119], v[200:203], v[160:163], v[116:119]
    ds_read_b64_tr_b16 v[198:199], v249 offset:9216
    v_add_f32 v230, v230, v141
    v_cvt_pk_bf16_f32 v190, v140, v141
    v_mfma_f32_16x16x32_bf16 v[100:103], v[204:207], v[168:171], v[100:103]
    v_exp_f32 v142, v142
    v_mfma_f32_16x16x32_bf16 v[108:111], v[204:207], v[176:179], v[108:111]
    ds_read_b64_tr_b16 v[200:201], v250 offset:8192
    v_add_f32 v230, v230, v142
    v_xor_b32 v248, s54, v248
    v_mfma_f32_16x16x32_bf16 v[116:119], v[204:207], v[184:187], v[116:119]
    s_waitcnt lgkmcnt(7)
    v_exp_f32 v143, v143
    v_mfma_f32_16x16x32_bf16 v[124:127], v[208:211], v[96:99], v[236:239]
    ds_read_b64_tr_b16 v[202:203], v250 offset:9216
    v_add_f32 v230, v230, v143
    v_cvt_pk_bf16_f32 v191, v142, v143
    v_mfma_f32_16x16x32_bf16 v[132:135], v[208:211], v[104:107], v[240:243]
    v_exp_f32 v100, v100
    v_mfma_f32_16x16x32_bf16 v[140:143], v[208:211], v[112:115], v[244:247]
    ds_read_b64_tr_b16 v[204:205], v251 offset:8192
    v_add_f32 v228, v228, v100
    v_xor_b32 v249, s54, v249
    v_mfma_f32_16x16x32_bf16 v[124:127], v[212:215], v[120:123], v[124:127]
    v_exp_f32 v101, v101
    v_mfma_f32_16x16x32_bf16 v[132:135], v[212:215], v[128:131], v[132:135]
    ds_read_b64_tr_b16 v[206:207], v251 offset:9216
    v_add_f32 v228, v228, v101
    v_cvt_pk_bf16_f32 v148, v100, v101
    v_mfma_f32_16x16x32_bf16 v[140:143], v[212:215], v[136:139], v[140:143]
    s_waitcnt lgkmcnt(8)
    v_exp_f32 v102, v102
    v_mfma_f32_16x16x32_bf16 v[124:127], v[216:219], v[144:147], v[124:127]
    ds_read_b64_tr_b16 v[208:209], v252 offset:8192
    v_add_f32 v228, v228, v102
    v_xor_b32 v250, s54, v250
    v_mfma_f32_16x16x32_bf16 v[132:135], v[216:219], v[152:155], v[132:135]
    v_exp_f32 v103, v103
    v_mfma_f32_16x16x32_bf16 v[140:143], v[216:219], v[160:163], v[140:143]
    ds_read_b64_tr_b16 v[210:211], v252 offset:9216
    v_add_f32 v228, v228, v103
    v_cvt_pk_bf16_f32 v149, v102, v103
    v_mfma_f32_16x16x32_bf16 v[124:127], v[220:223], v[168:171], v[124:127]
    v_exp_f32 v108, v108
    v_mfma_f32_16x16x32_bf16 v[132:135], v[220:223], v[176:179], v[132:135]
    ds_read_b64_tr_b16 v[212:213], v253 offset:8192
    v_add_f32 v229, v229, v108
    v_xor_b32 v251, s54, v251
    v_mfma_f32_16x16x32_bf16 v[140:143], v[220:223], v[184:187], v[140:143]
    s_waitcnt lgkmcnt(7)
    v_exp_f32 v109, v109
    v_mfma_f32_16x16x32_bf16 v[0:3], v[192:195], v[172:175], v[0:3]
    ds_read_b64_tr_b16 v[214:215], v253 offset:9216
    v_add_f32 v229, v229, v109
    v_cvt_pk_bf16_f32 v156, v108, v109
    v_mfma_f32_16x16x32_bf16 v[32:35], v[192:195], v[180:183], v[32:35]
    v_exp_f32 v110, v110
    v_mfma_f32_16x16x32_bf16 v[64:67], v[192:195], v[188:191], v[64:67]
    ds_read_b64_tr_b16 v[216:217], v254 offset:8192
    v_add_f32 v229, v229, v110
    v_xor_b32 v252, s54, v252
    v_mfma_f32_16x16x32_bf16 v[4:7], v[196:199], v[172:175], v[4:7]
    v_exp_f32 v111, v111
    v_mfma_f32_16x16x32_bf16 v[36:39], v[196:199], v[180:183], v[36:39]
    ds_read_b64_tr_b16 v[218:219], v254 offset:9216
    v_add_f32 v229, v229, v111
    v_cvt_pk_bf16_f32 v157, v110, v111
    v_mfma_f32_16x16x32_bf16 v[68:71], v[196:199], v[188:191], v[68:71]
    s_waitcnt lgkmcnt(6)
    v_exp_f32 v116, v116
    v_mfma_f32_16x16x32_bf16 v[8:11], v[200:203], v[172:175], v[8:11]
    ds_read_b64_tr_b16 v[220:221], v255 offset:8192
    v_add_f32 v230, v230, v116
    v_xor_b32 v253, s54, v253
    v_mfma_f32_16x16x32_bf16 v[40:43], v[200:203], v[180:183], v[40:43]
    v_exp_f32 v117, v117
    v_mfma_f32_16x16x32_bf16 v[72:75], v[200:203], v[188:191], v[72:75]
    ds_read_b64_tr_b16 v[222:223], v255 offset:9216
    v_add_f32 v230, v230, v117
    v_cvt_pk_bf16_f32 v164, v116, v117
    v_mfma_f32_16x16x32_bf16 v[12:15], v[204:207], v[172:175], v[12:15]
    v_exp_f32 v118, v118
    v_mfma_f32_16x16x32_bf16 v[44:47], v[204:207], v[180:183], v[44:47]
    ds_read_b128 v[192:195], v224 offset:8192
    v_add_f32 v230, v230, v118
    v_xor_b32 v254, s54, v254
    v_mfma_f32_16x16x32_bf16 v[76:79], v[204:207], v[188:191], v[76:79]
    s_waitcnt lgkmcnt(5)
    v_exp_f32 v119, v119
    v_mfma_f32_16x16x32_bf16 v[16:19], v[208:211], v[172:175], v[16:19]
    ds_read_b128 v[196:199], v225 offset:8192
    v_add_f32 v230, v230, v119
    v_cvt_pk_bf16_f32 v165, v118, v119
    v_mfma_f32_16x16x32_bf16 v[48:51], v[208:211], v[180:183], v[48:51]
    v_exp_f32 v124, v124
    v_mfma_f32_16x16x32_bf16 v[80:83], v[208:211], v[188:191], v[80:83]
    ds_read_b128 v[200:203], v226 offset:8192
    v_add_f32 v228, v228, v124
    v_xor_b32 v255, s54, v255
    v_mfma_f32_16x16x32_bf16 v[20:23], v[212:215], v[172:175], v[20:23]
    v_exp_f32 v125, v125
    v_mfma_f32_16x16x32_bf16 v[52:55], v[212:215], v[180:183], v[52:55]
    ds_read_b128 v[204:207], v227 offset:8192
    v_add_f32 v228, v228, v125
    v_cvt_pk_bf16_f32 v150, v124, v125
    v_mfma_f32_16x16x32_bf16 v[84:87], v[212:215], v[188:191], v[84:87]
    s_waitcnt lgkmcnt(4)
    v_exp_f32 v126, v126
    v_mfma_f32_16x16x32_bf16 v[24:27], v[216:219], v[172:175], v[24:27]
    ds_read_b128 v[208:211], v224 offset:9216
    v_add_f32 v228, v228, v126
    v_mfma_f32_16x16x32_bf16 v[56:59], v[216:219], v[180:183], v[56:59]
    v_exp_f32 v127, v127
    v_mfma_f32_16x16x32_bf16 v[88:91], v[216:219], v[188:191], v[88:91]
    ds_read_b128 v[212:215], v225 offset:9216
    v_add_f32 v228, v228, v127
    v_cvt_pk_bf16_f32 v151, v126, v127
    v_mfma_f32_16x16x32_bf16 v[28:31], v[220:223], v[172:175], v[28:31]
    v_exp_f32 v132, v132
    v_mfma_f32_16x16x32_bf16 v[60:63], v[220:223], v[180:183], v[60:63]
    ds_read_b128 v[216:219], v226 offset:9216
    v_add_f32 v229, v229, v132
    v_mfma_f32_16x16x32_bf16 v[92:95], v[220:223], v[188:191], v[92:95]
    s_waitcnt lgkmcnt(5)
    v_exp_f32 v133, v133
    s_branch L_p2
L_tail:
    ds_read_b64_tr_b16 v[192:193], v248 offset:8192
    v_add_f32 v229, v229, v133
    ds_read_b64_tr_b16 v[194:195], v248 offset:9216
    v_cvt_pk_bf16_f32 v182, v132, v133
    ds_read_b64_tr_b16 v[196:197], v249 offset:8192
    v_exp_f32 v134, v134
    ds_read_b64_tr_b16 v[198:199], v249 offset:9216
    v_add_f32 v229, v229, v134
    ds_read_b64_tr_b16 v[200:201], v250 offset:8192
    v_exp_f32 v135, v135
    ds_read_b64_tr_b16 v[202:203], v250 offset:9216
    v_add_f32 v229, v229, v135
    ds_read_b64_tr_b16 v[204:205], v251 offset:8192
    v_cvt_pk_bf16_f32 v183, v134, v135
    ds_read_b64_tr_b16 v[206:207], v251 offset:9216
    v_exp_f32 v140, v140
    ds_read_b64_tr_b16 v[208:209], v252 offset:8192
    v_add_f32 v230, v230, v140
    ds_read_b64_tr_b16 v[210:211], v252 offset:9216
    v_exp_f32 v141, v141
    ds_read_b64_tr_b16 v[212:213], v253 offset:8192
    v_add_f32 v230, v230, v141
    ds_read_b64_tr_b16 v[214:215], v253 offset:9216
    v_cvt_pk_bf16_f32 v190, v140, v141
    ds_read_b64_tr_b16 v[216:217], v254 offset:8192
    v_exp_f32 v142, v142
    ds_read_b64_tr_b16 v[218:219], v254 offset:9216
    v_add_f32 v230, v230, v142
    ds_read_b64_tr_b16 v[220:221], v255 offset:8192
    v_exp_f32 v143, v143
    ds_read_b64_tr_b16 v[222:223], v255 offset:9216
    v_add_f32 v230, v230, v143
    v_cvt_pk_bf16_f32 v191, v142, v143
    s_waitcnt lgkmcnt(14)
    v_mfma_f32_16x16x32_bf16 v[0:3], v[192:195], v[172:175], v[0:3]
    v_mov_b32 v231, v228
    v_mov_b32 v232, v229
    v_mov_b32 v233, v230
    v_mfma_f32_16x16x32_bf16 v[32:35], v[192:195], v[180:183], v[32:35]
    s_nop 1
    v_permlane16_swap_b32 v228, v231
    v_permlane16_swap_b32 v229, v232
    v_mfma_f32_16x16x32_bf16 v[64:67], v[192:195], v[188:191], v[64:67]
    v_permlane16_swap_b32 v230, v233
    s_nop 0
    v_add_f32 v228, v228, v231
    s_waitcnt lgkmcnt(12)
    v_mfma_f32_16x16x32_bf16 v[4:7], v[196:199], v[172:175], v[4:7]
    v_add_f32 v229, v229, v232
    v_add_f32 v230, v230, v233
    v_mov_b32 v231, v228
    v_mfma_f32_16x16x32_bf16 v[36:39], v[196:199], v[180:183], v[36:39]
    v_mov_b32 v232, v229
    v_mov_b32 v233, v230
    s_nop 1
    v_mfma_f32_16x16x32_bf16 v[68:71], v[196:199], v[188:191], v[68:71]
    v_permlane32_swap_b32 v228, v231
    v_permlane32_swap_b32 v229, v232
    v_permlane32_swap_b32 v230, v233
    s_waitcnt lgkmcnt(10)
    v_mfma_f32_16x16x32_bf16 v[8:11], v[200:203], v[172:175], v[8:11]
    s_nop 0
    v_add_f32 v228, v228, v231
    v_add_f32 v229, v229, v232
    v_mfma_f32_16x16x32_bf16 v[40:43], v[200:203], v[180:183], v[40:43]
    v_add_f32 v230, v230, v233
    v_max3_f32 v231, v228, v229, v230
    v_add_f32 v232, v228, v229
    v_mfma_f32_16x16x32_bf16 v[72:75], v[200:203], v[188:191], v[72:75]
    v_rcp_f32 v228, v228
    v_rcp_f32 v229, v229
    v_cmp_nge_f32 vcc, s57, v231
    s_waitcnt lgkmcnt(8)
    v_mfma_f32_16x16x32_bf16 v[12:15], v[204:207], v[172:175], v[12:15]
    v_cmp_u_f32 s[70:71], v232, v230
    v_rcp_f32 v230, v230
    v_mbcnt_lo_u32_b32 v235, -1, 0
    v_mfma_f32_16x16x32_bf16 v[44:47], v[204:207], v[180:183], v[44:47]
    v_mbcnt_hi_u32_b32 v235, -1, v235
    v_lshlrev_b32 v235, 4, v235
    s_lshl_b32 s45, s46, 2
    v_mfma_f32_16x16x32_bf16 v[76:79], v[204:207], v[188:191], v[76:79]
    s_add_u32 s45, s45, 49152
    s_or_b64 vcc, vcc, s[70:71]
    s_cselect_b32 s44, 1, 0
    s_waitcnt lgkmcnt(6)
    v_mfma_f32_16x16x32_bf16 v[16:19], v[208:211], v[172:175], v[16:19]
    s_andn2_b32 s44, s44, s62
    v_mov_b32 v231, s45
    v_mov_b32 v232, s44
    v_mfma_f32_16x16x32_bf16 v[48:51], v[208:211], v[180:183], v[48:51]
    ds_write_b32 v231, v232
    v_mul_f32 v0, v0, v228
    v_mul_f32 v1, v1, v228
    v_mfma_f32_16x16x32_bf16 v[80:83], v[208:211], v[188:191], v[80:83]
    v_mul_f32 v2, v2, v228
    v_mul_f32 v3, v3, v228
    v_mul_f32 v4, v4, v228
    s_waitcnt lgkmcnt(5)
    v_mfma_f32_16x16x32_bf16 v[20:23], v[212:215], v[172:175], v[20:23]
    v_mul_f32 v5, v5, v228
    v_mul_f32 v6, v6, v228
    v_mul_f32 v7, v7, v228
    v_mfma_f32_16x16x32_bf16 v[52:55], v[212:215], v[180:183], v[52:55]
    v_cvt_pk_bf16_f32 v0, v0, v1
    v_cvt_pk_bf16_f32 v1, v2, v3
    v_cvt_pk_bf16_f32 v2, v4, v5
    v_mfma_f32_16x16x32_bf16 v[84:87], v[212:215], v[188:191], v[84:87]
    v_cvt_pk_bf16_f32 v3, v6, v7
    buffer_store_dwordx4 v[0:3], v235, s[36:39], s59 offen offset:0 sc1
    v_mul_f32 v32, v32, v229
    s_waitcnt lgkmcnt(3)
    v_mfma_f32_16x16x32_bf16 v[24:27], v[216:219], v[172:175], v[24:27]
    v_mul_f32 v33, v33, v229
    v_mul_f32 v34, v34, v229
    v_mul_f32 v35, v35, v229
    v_mfma_f32_16x16x32_bf16 v[56:59], v[216:219], v[180:183], v[56:59]
    v_mul_f32 v36, v36, v229
    v_mul_f32 v37, v37, v229
    v_mul_f32 v38, v38, v229
    v_mfma_f32_16x16x32_bf16 v[88:91], v[216:219], v[188:191], v[88:91]
    v_mul_f32 v39, v39, v229
    v_cvt_pk_bf16_f32 v32, v32, v33
    v_cvt_pk_bf16_f32 v33, v34, v35
    s_waitcnt lgkmcnt(1)
    v_mfma_f32_16x16x32_bf16 v[28:31], v[220:223], v[172:175], v[28:31]
    v_cvt_pk_bf16_f32 v34, v36, v37
    v_cvt_pk_bf16_f32 v35, v38, v39
    buffer_store_dwordx4 v[32:35], v235, s[36:39], s60 offen offset:0 sc1
    s_waitcnt lgkmcnt(0)
    s_barrier
    v_mov_b32 v192, 49152
    ds_read_b128 v[192:195], v192
    v_mfma_f32_16x16x32_bf16 v[60:63], v[220:223], v[180:183], v[60:63]
    v_mul_f32 v64, v64, v230
    v_mul_f32 v65, v65, v230
    v_mul_f32 v66, v66, v230
    v_mfma_f32_16x16x32_bf16 v[92:95], v[220:223], v[188:191], v[92:95]
    v_mul_f32 v67, v67, v230
    v_mul_f32 v68, v68, v230
    v_mul_f32 v69, v69, v230
    v_mul_f32 v70, v70, v230
    v_mul_f32 v71, v71, v230
    v_cvt_pk_bf16_f32 v64, v64, v65
    v_cvt_pk_bf16_f32 v65, v66, v67
    v_cvt_pk_bf16_f32 v66, v68, v69
    v_cvt_pk_bf16_f32 v67, v70, v71
    buffer_store_dwordx4 v[64:67], v235, s[36:39], s61 offen offset:0 sc1
    v_mul_f32 v8, v8, v228
    v_mul_f32 v9, v9, v228
    v_mul_f32 v10, v10, v228
    v_mul_f32 v11, v11, v228
    v_mul_f32 v12, v12, v228
    v_mul_f32 v13, v13, v228
    v_mul_f32 v14, v14, v228
    v_mul_f32 v15, v15, v228
    v_cvt_pk_bf16_f32 v8, v8, v9
    v_cvt_pk_bf16_f32 v9, v10, v11
    v_cvt_pk_bf16_f32 v10, v12, v13
    v_cvt_pk_bf16_f32 v11, v14, v15
    buffer_store_dwordx4 v[8:11], v235, s[36:39], s59 offen offset:1024 sc1
    v_mul_f32 v40, v40, v229
    v_mul_f32 v41, v41, v229
    v_mul_f32 v42, v42, v229
    v_mul_f32 v43, v43, v229
    v_mul_f32 v44, v44, v229
    v_mul_f32 v45, v45, v229
    v_mul_f32 v46, v46, v229
    v_mul_f32 v47, v47, v229
    v_cvt_pk_bf16_f32 v40, v40, v41
    v_cvt_pk_bf16_f32 v41, v42, v43
    v_cvt_pk_bf16_f32 v42, v44, v45
    v_cvt_pk_bf16_f32 v43, v46, v47
    buffer_store_dwordx4 v[40:43], v235, s[36:39], s60 offen offset:1024 sc1
    v_mul_f32 v72, v72, v230
    v_mul_f32 v73, v73, v230
    v_mul_f32 v74, v74, v230
    v_mul_f32 v75, v75, v230
    v_mul_f32 v76, v76, v230
    v_mul_f32 v77, v77, v230
    v_mul_f32 v78, v78, v230
    v_mul_f32 v79, v79, v230
    v_cvt_pk_bf16_f32 v72, v72, v73
    v_cvt_pk_bf16_f32 v73, v74, v75
    v_cvt_pk_bf16_f32 v74, v76, v77
    v_cvt_pk_bf16_f32 v75, v78, v79
    buffer_store_dwordx4 v[72:75], v235, s[36:39], s61 offen offset:1024 sc1
    v_mul_f32 v16, v16, v228
    v_mul_f32 v17, v17, v228
    v_mul_f32 v18, v18, v228
    v_mul_f32 v19, v19, v228
    v_mul_f32 v20, v20, v228
    v_mul_f32 v21, v21, v228
    v_mul_f32 v22, v22, v228
    v_mul_f32 v23, v23, v228
    v_cvt_pk_bf16_f32 v16, v16, v17
    v_cvt_pk_bf16_f32 v17, v18, v19
    v_cvt_pk_bf16_f32 v18, v20, v21
    v_cvt_pk_bf16_f32 v19, v22, v23
    buffer_store_dwordx4 v[16:19], v235, s[36:39], s59 offen offset:2048 sc1
    v_mul_f32 v48, v48, v229
    v_mul_f32 v49, v49, v229
    v_mul_f32 v50, v50, v229
    v_mul_f32 v51, v51, v229
    v_mul_f32 v52, v52, v229
    v_mul_f32 v53, v53, v229
    v_mul_f32 v54, v54, v229
    v_mul_f32 v55, v55, v229
    v_cvt_pk_bf16_f32 v48, v48, v49
    v_cvt_pk_bf16_f32 v49, v50, v51
    v_cvt_pk_bf16_f32 v50, v52, v53
    v_cvt_pk_bf16_f32 v51, v54, v55
    buffer_store_dwordx4 v[48:51], v235, s[36:39], s60 offen offset:2048 sc1
    v_mul_f32 v80, v80, v230
    v_mul_f32 v81, v81, v230
    v_mul_f32 v82, v82, v230
    v_mul_f32 v83, v83, v230
    v_mul_f32 v84, v84, v230
    v_mul_f32 v85, v85, v230
    v_mul_f32 v86, v86, v230
    v_mul_f32 v87, v87, v230
    v_cvt_pk_bf16_f32 v80, v80, v81
    v_cvt_pk_bf16_f32 v81, v82, v83
    v_cvt_pk_bf16_f32 v82, v84, v85
    v_cvt_pk_bf16_f32 v83, v86, v87
    buffer_store_dwordx4 v[80:83], v235, s[36:39], s61 offen offset:2048 sc1
    v_mul_f32 v24, v24, v228
    v_mul_f32 v25, v25, v228
    v_mul_f32 v26, v26, v228
    v_mul_f32 v27, v27, v228
    v_mul_f32 v28, v28, v228
    v_mul_f32 v29, v29, v228
    v_mul_f32 v30, v30, v228
    v_mul_f32 v31, v31, v228
    v_cvt_pk_bf16_f32 v24, v24, v25
    v_cvt_pk_bf16_f32 v25, v26, v27
    v_cvt_pk_bf16_f32 v26, v28, v29
    v_cvt_pk_bf16_f32 v27, v30, v31
    buffer_store_dwordx4 v[24:27], v235, s[36:39], s59 offen offset:3072 sc1
    v_mul_f32 v56, v56, v229
    v_mul_f32 v57, v57, v229
    v_mul_f32 v58, v58, v229
    v_mul_f32 v59, v59, v229
    v_mul_f32 v60, v60, v229
    v_mul_f32 v61, v61, v229
    v_mul_f32 v62, v62, v229
    v_mul_f32 v63, v63, v229
    v_cvt_pk_bf16_f32 v56, v56, v57
    v_cvt_pk_bf16_f32 v57, v58, v59
    v_cvt_pk_bf16_f32 v58, v60, v61
    v_cvt_pk_bf16_f32 v59, v62, v63
    buffer_store_dwordx4 v[56:59], v235, s[36:39], s60 offen offset:3072 sc1
    v_mul_f32 v88, v88, v230
    v_mul_f32 v89, v89, v230
    v_mul_f32 v90, v90, v230
    v_mul_f32 v91, v91, v230
    v_mul_f32 v92, v92, v230
    v_mul_f32 v93, v93, v230
    v_mul_f32 v94, v94, v230
    v_mul_f32 v95, v95, v230
    v_cvt_pk_bf16_f32 v88, v88, v89
    v_cvt_pk_bf16_f32 v89, v90, v91
    v_cvt_pk_bf16_f32 v90, v92, v93
    v_cvt_pk_bf16_f32 v91, v94, v95
    buffer_store_dwordx4 v[88:91], v235, s[36:39], s61 offen offset:3072 sc1
    s_waitcnt lgkmcnt(0)
    v_or3_b32 v192, v192, v193, v194
    v_or_b32 v192, v192, v195
    s_nop 0
    v_readfirstlane_b32 s44, v192
    s_nop 0
    s_cmp_lg_u32 s44, 0
    s_cbranch_scc1 L_redo
    v_mov_b32 v252, v235
    s_cmp_ge_u32 s67, 8
    s_cselect_b32 s81, 0xfff70000, 0
    s_add_u32 s44, s76, s81
    buffer_load_dwordx4 v[192:195], v252, s[36:39], s44 offen sc1
    s_add_u32 s44, s76, s81
    s_add_u32 s44, s44, 8192
    buffer_load_dwordx4 v[204:207], v252, s[36:39], s44 offen sc1
    s_add_u32 s44, s76, s81
    s_add_u32 s44, s44, 16384
    buffer_load_dwordx4 v[216:219], v252, s[36:39], s44 offen sc1
    s_add_u32 s44, s76, s81
    s_add_u32 s44, s44, 24576
    buffer_load_dwordx4 v[228:231], v252, s[36:39], s44 offen sc1
    s_add_u32 s44, s76, s81
    s_add_u32 s44, s44, 32768
    buffer_load_dwordx4 v[196:199], v252, s[36:39], s44 offen sc1
    s_add_u32 s44, s76, s81
    s_add_u32 s44, s44, 40960
    buffer_load_dwordx4 v[208:211], v252, s[36:39], s44 offen sc1
    s_add_u32 s44, s76, s81
    s_add_u32 s44, s44, 49152
    buffer_load_dwordx4 v[220:223], v252, s[36:39], s44 offen sc1
    s_add_u32 s44, s76, s81
    s_add_u32 s44, s44, 57344
    buffer_load_dwordx4 v[232:235], v252, s[36:39], s44 offen sc1
    s_lshl_b32 s44, s66, 10
    v_add_u32 v253, s44, v252
    v_add_u32 v254, 65536, v253
    v_add_u32 v255, 131072, v253
    s_setprio 0
    s_waitcnt vmcnt(8)
    s_barrier
    s_add_u32 s44, s76, s81
    s_add_u32 s44, s44, 65536
    buffer_load_dwordx4 v[248:251], v252, s[36:39], s44 offen sc1
    s_cmp_ge_u32 s67, 7
    s_cselect_b32 s81, 589824, 0
    s_sub_u32 s81, 73728, s81
    s_add_u32 s44, s76, s81
    buffer_load_dwordx4 v[0:3], v252, s[36:39], s44 offen sc1
    s_add_u32 s44, s76, s81
    s_add_u32 s44, s44, 8192
    buffer_load_dwordx4 v[4:7], v252, s[36:39], s44 offen sc1
    s_add_u32 s44, s76, s81
    s_add_u32 s44, s44, 16384
    buffer_load_dwordx4 v[8:11], v252, s[36:39], s44 offen sc1
    s_add_u32 s44, s76, s81
    s_add_u32 s44, s44, 24576
    buffer_load_dwordx4 v[12:15], v252, s[36:39], s44 offen sc1
    s_add_u32 s44, s76, s81
    s_add_u32 s44, s44, 32768
    buffer_load_dwordx4 v[16:19], v252, s[36:39], s44 offen sc1
    s_add_u32 s44, s76, s81
    s_add_u32 s44, s44, 40960
    buffer_load_dwordx4 v[20:23], v252, s[36:39], s44 offen sc1
    s_add_u32 s44, s76, s81
    s_add_u32 s44, s44, 49152
    buffer_load_dwordx4 v[24:27], v252, s[36:39], s44 offen sc1
    s_add_u32 s44, s76, s81
    s_add_u32 s44, s44, 57344
    buffer_load_dwordx4 v[28:31], v252, s[36:39], s44 offen sc1
    s_add_u32 s44, s76, s81
    s_add_u32 s44, s44, 65536
    buffer_load_dwordx4 v[32:35], v252, s[36:39], s44 offen sc1
    s_cmp_ge_u32 s67, 6
    s_cselect_b32 s81, 589824, 0
    s_sub_u32 s81, 147456, s81
    s_add_u32 s44, s76, s81
    buffer_load_dwordx4 v[36:39], v252, s[36:39], s44 offen sc1
    s_add_u32 s44, s76, s81
    s_add_u32 s44, s44, 8192
    buffer_load_dwordx4 v[40:43], v252, s[36:39], s44 offen sc1
    s_add_u32 s44, s76, s81
    s_add_u32 s44, s44, 16384
    buffer_load_dwordx4 v[44:47], v252, s[36:39], s44 offen sc1
    s_add_u32 s44, s76, s81
    s_add_u32 s44, s44, 24576
    buffer_load_dwordx4 v[48:51], v252, s[36:39], s44 offen sc1
    s_add_u32 s44, s76, s81
    s_add_u32 s44, s44, 32768
    buffer_load_dwordx4 v[52:55], v252, s[36:39], s44 offen sc1
    s_add_u32 s44, s76, s81
    s_add_u32 s44, s44, 40960
    buffer_load_dwordx4 v[56:59], v252, s[36:39], s44 offen sc1
    s_add_u32 s44, s76, s81
    s_add_u32 s44, s44, 49152
    buffer_load_dwordx4 v[60:63], v252, s[36:39], s44 offen sc1
    s_add_u32 s44, s76, s81
    s_add_u32 s44, s44, 57344
    buffer_load_dwordx4 v[64:67], v252, s[36:39], s44 offen sc1
    s_add_u32 s44, s76, s81
    s_add_u32 s44, s44, 65536
    buffer_load_dwordx4 v[68:71], v252, s[36:39], s44 offen sc1
    s_cmp_ge_u32 s67, 5
    s_cselect_b32 s81, 589824, 0
    s_sub_u32 s81, 221184, s81
    s_add_u32 s44, s76, s81
    buffer_load_dwordx4 v[72:75], v252, s[36:39], s44 offen sc1
    s_add_u32 s44, s76, s81
    s_add_u32 s44, s44, 8192
    buffer_load_dwordx4 v[76:79], v252, s[36:39], s44 offen sc1
    s_add_u32 s44, s76, s81
    s_add_u32 s44, s44, 16384
    buffer_load_dwordx4 v[80:83], v252, s[36:39], s44 offen sc1
    s_add_u32 s44, s76, s81
    s_add_u32 s44, s44, 24576
    buffer_load_dwordx4 v[84:87], v252, s[36:39], s44 offen sc1
    s_add_u32 s44, s76, s81
    s_add_u32 s44, s44, 32768
    buffer_load_dwordx4 v[88:91], v252, s[36:39], s44 offen sc1
    s_add_u32 s44, s76, s81
    s_add_u32 s44, s44, 40960
    buffer_load_dwordx4 v[92:95], v252, s[36:39], s44 offen sc1
    s_add_u32 s44, s76, s81
    s_add_u32 s44, s44, 49152
    buffer_load_dwordx4 v[96:99], v252, s[36:39], s44 offen sc1
    s_add_u32 s44, s76, s81
    s_add_u32 s44, s44, 57344
    buffer_load_dwordx4 v[100:103], v252, s[36:39], s44 offen sc1
    s_add_u32 s44, s76, s81
    s_add_u32 s44, s44, 65536
    buffer_load_dwordx4 v[104:107], v252, s[36:39], s44 offen sc1
    s_cmp_ge_u32 s67, 4
    s_cselect_b32 s81, 589824, 0
    s_sub_u32 s81, 294912, s81
    s_add_u32 s44, s76, s81
    buffer_load_dwordx4 v[108:111], v252, s[36:39], s44 offen sc1
    s_add_u32 s44, s76, s81
    s_add_u32 s44, s44, 8192
    buffer_load_dwordx4 v[112:115], v252, s[36:39], s44 offen sc1
    s_add_u32 s44, s76, s81
    s_add_u32 s44, s44, 16384
    buffer_load_dwordx4 v[116:119], v252, s[36:39], s44 offen sc1
    s_add_u32 s44, s76, s81
    s_add_u32 s44, s44, 24576
    buffer_load_dwordx4 v[120:123], v252, s[36:39], s44 offen sc1
    s_add_u32 s44, s76, s81
    s_add_u32 s44, s44, 32768
    buffer_load_dwordx4 v[124:127], v252, s[36:39], s44 offen sc1
    s_add_u32 s44, s76, s81
    s_add_u32 s44, s44, 40960
    buffer_load_dwordx4 v[128:131], v252, s[36:39], s44 offen sc1
    s_add_u32 s44, s76, s81
    s_add_u32 s44, s44, 49152
    buffer_load_dwordx4 v[132:135], v252, s[36:39], s44 offen sc1
    s_add_u32 s44, s76, s81
    s_add_u32 s44, s44, 57344
    buffer_load_dwordx4 v[136:139], v252, s[36:39], s44 offen sc1
    s_add_u32 s44, s76, s81
    s_add_u32 s44, s44, 65536
    buffer_load_dwordx4 v[140:143], v252, s[36:39], s44 offen sc1
L_op:
    s_mov_b32 s32, s14
    s_mov_b32 s33, s15
    s_mov_b32 s34, 0x1b0000
    s_mov_b32 s35, 0x00020000
    s_mov_b32 s48, 16384
    s_barrier
    buffer_load_dwordx4 v[240:243], v252, s[36:39], s78 offen offset:0 sc1
    buffer_load_dwordx4 v[244:247], v252, s[36:39], s79 offen offset:0 sc1
    buffer_load_dwordx4 v[144:147], v252, s[36:39], s80 offen offset:0 sc1
    buffer_load_dwordx4 v[148:151], v252, s[36:39], s78 offen offset:1024 sc1
    s_cmp_eq_u32 s67, 7
    s_cselect_b32 s65, 0xfffe4000, s48
    s_add_u32 s78, s78, s65
    buffer_load_dwordx4 v[152:155], v252, s[36:39], s79 offen offset:1024 sc1
    s_add_u32 s79, s79, s65
    buffer_load_dwordx4 v[156:159], v252, s[36:39], s80 offen offset:1024 sc1
    s_add_u32 s80, s80, s65
    buffer_load_dwordx4 v[160:163], v252, s[36:39], s78 offen offset:0 sc1
    buffer_load_dwordx4 v[164:167], v252, s[36:39], s79 offen offset:0 sc1
    s_waitcnt vmcnt(7)
    v_mfma_f32_16x16x32_bf16 v[180:183], v[192:195], v[240:243], 0
    s_waitcnt vmcnt(6)
    v_mfma_f32_16x16x32_bf16 v[184:187], v[192:195], v[244:247], 0
    s_waitcnt vmcnt(5)
    v_mfma_f32_16x16x32_bf16 v[188:191], v[192:195], v[144:147], 0
    s_waitcnt vmcnt(4)
    v_mfma_f32_16x16x32_bf16 v[180:183], v[196:199], v[148:151], v[180:183]
    s_waitcnt vmcnt(3)
    v_mfma_f32_16x16x32_bf16 v[184:187], v[196:199], v[152:155], v[184:187]
    s_waitcnt vmcnt(2)
    v_mfma_f32_16x16x32_bf16 v[188:191], v[196:199], v[156:159], v[188:191]
    v_mfma_f32_16x16x32_bf16 v[192:195], v[204:207], v[240:243], 0
    v_mfma_f32_16x16x32_bf16 v[196:199], v[204:207], v[244:247], 0
    v_mfma_f32_16x16x32_bf16 v[200:203], v[204:207], v[144:147], 0
    v_mfma_f32_16x16x32_bf16 v[192:195], v[208:211], v[148:151], v[192:195]
    v_mfma_f32_16x16x32_bf16 v[196:199], v[208:211], v[152:155], v[196:199]
    v_mfma_f32_16x16x32_bf16 v[200:203], v[208:211], v[156:159], v[200:203]
    v_mfma_f32_16x16x32_bf16 v[204:207], v[216:219], v[240:243], 0
    v_mfma_f32_16x16x32_bf16 v[208:211], v[216:219], v[244:247], 0
    v_mfma_f32_16x16x32_bf16 v[212:215], v[216:219], v[144:147], 0
    v_mfma_f32_16x16x32_bf16 v[204:207], v[220:223], v[148:151], v[204:207]
    v_mfma_f32_16x16x32_bf16 v[208:211], v[220:223], v[152:155], v[208:211]
    v_mfma_f32_16x16x32_bf16 v[212:215], v[220:223], v[156:159], v[212:215]
    v_mfma_f32_16x16x32_bf16 v[216:219], v[228:231], v[240:243], 0
    v_mfma_f32_16x16x32_bf16 v[220:223], v[228:231], v[244:247], 0
    v_mfma_f32_16x16x32_bf16 v[224:227], v[228:231], v[144:147], 0
    v_mfma_f32_16x16x32_bf16 v[216:219], v[232:235], v[148:151], v[216:219]
    v_mfma_f32_16x16x32_bf16 v[220:223], v[232:235], v[152:155], v[220:223]
    v_mfma_f32_16x16x32_bf16 v[224:227], v[232:235], v[156:159], v[224:227]
    v_mfma_f32_16x16x32_bf16 v[228:231], v[248:251], v[240:243], 0
    v_mfma_f32_16x16x32_bf16 v[232:235], v[248:251], v[244:247], 0
    v_mfma_f32_16x16x32_bf16 v[236:239], v[248:251], v[144:147], 0
    buffer_load_dwordx4 v[168:171], v252, s[36:39], s80 offen offset:0 sc1
    buffer_load_dwordx4 v[172:175], v252, s[36:39], s78 offen offset:1024 sc1
    s_cmp_eq_u32 s67, 6
    s_cselect_b32 s65, 0xfffe4000, s48
    s_add_u32 s78, s78, s65
    buffer_load_dwordx4 v[176:179], v252, s[36:39], s79 offen offset:1024 sc1
    s_add_u32 s79, s79, s65
    v_mfma_f32_16x16x32_bf16 v[240:243], v[248:251], v[148:151], 0
    buffer_load_dwordx4 v[144:147], v252, s[36:39], s80 offen offset:1024 sc1
    s_add_u32 s80, s80, s65
    v_mfma_f32_16x16x32_bf16 v[244:247], v[248:251], v[152:155], 0
    buffer_load_dwordx4 v[148:151], v252, s[36:39], s78 offen offset:0 sc1
    v_mfma_f32_16x16x32_bf16 v[248:251], v[248:251], v[156:159], 0
    buffer_load_dwordx4 v[152:155], v252, s[36:39], s79 offen offset:0 sc1
    s_waitcnt vmcnt(7)
    v_mfma_f32_16x16x32_bf16 v[180:183], v[0:3], v[160:163], v[180:183]
    v_mfma_f32_16x16x32_bf16 v[192:195], v[4:7], v[160:163], v[192:195]
    v_mfma_f32_16x16x32_bf16 v[204:207], v[8:11], v[160:163], v[204:207]
    v_mfma_f32_16x16x32_bf16 v[216:219], v[12:15], v[160:163], v[216:219]
    v_mfma_f32_16x16x32_bf16 v[228:231], v[32:35], v[160:163], v[228:231]
    buffer_load_dwordx4 v[156:159], v252, s[36:39], s80 offen offset:0 sc1
    s_waitcnt vmcnt(7)
    v_mfma_f32_16x16x32_bf16 v[184:187], v[0:3], v[164:167], v[184:187]
    v_mfma_f32_16x16x32_bf16 v[196:199], v[4:7], v[164:167], v[196:199]
    v_mfma_f32_16x16x32_bf16 v[208:211], v[8:11], v[164:167], v[208:211]
    v_mfma_f32_16x16x32_bf16 v[220:223], v[12:15], v[164:167], v[220:223]
    v_mfma_f32_16x16x32_bf16 v[232:235], v[32:35], v[164:167], v[232:235]
    buffer_load_dwordx4 v[160:163], v252, s[36:39], s78 offen offset:1024 sc1
    s_cmp_eq_u32 s67, 5
    s_cselect_b32 s65, 0xfffe4000, s48
    s_add_u32 s78, s78, s65
    s_waitcnt vmcnt(7)
    v_mfma_f32_16x16x32_bf16 v[188:191], v[0:3], v[168:171], v[188:191]
    v_mfma_f32_16x16x32_bf16 v[200:203], v[4:7], v[168:171], v[200:203]
    v_mfma_f32_16x16x32_bf16 v[212:215], v[8:11], v[168:171], v[212:215]
    v_mfma_f32_16x16x32_bf16 v[224:227], v[12:15], v[168:171], v[224:227]
    v_mfma_f32_16x16x32_bf16 v[236:239], v[32:35], v[168:171], v[236:239]
    s_cmp_ge_u32 s67, 1
    s_cselect_b32 s81, 589824, 0
    s_sub_u32 s81, 516096, s81
    s_add_u32 s44, s76, s81
    s_add_u32 s44, s44, 16384
    buffer_load_dwordx4 v[164:167], v252, s[36:39], s44 offen sc1
    buffer_load_dwordx4 v[168:171], v252, s[36:39], s79 offen offset:1024 sc1
    s_add_u32 s79, s79, s65
    s_waitcnt vmcnt(8)
    v_mfma_f32_16x16x32_bf16 v[180:183], v[16:19], v[172:175], v[180:183]
    v_mfma_f32_16x16x32_bf16 v[192:195], v[20:23], v[172:175], v[192:195]
    v_mfma_f32_16x16x32_bf16 v[204:207], v[24:27], v[172:175], v[204:207]
    v_mfma_f32_16x16x32_bf16 v[216:219], v[28:31], v[172:175], v[216:219]
    v_mfma_f32_16x16x32_bf16 v[240:243], v[32:35], v[172:175], v[240:243]
    buffer_load_dwordx4 v[0:3], v252, s[36:39], s80 offen offset:1024 sc1
    s_add_u32 s80, s80, s65
    s_waitcnt vmcnt(8)
    v_mfma_f32_16x16x32_bf16 v[184:187], v[16:19], v[176:179], v[184:187]
    v_mfma_f32_16x16x32_bf16 v[196:199], v[20:23], v[176:179], v[196:199]
    v_mfma_f32_16x16x32_bf16 v[208:211], v[24:27], v[176:179], v[208:211]
    v_mfma_f32_16x16x32_bf16 v[220:223], v[28:31], v[176:179], v[220:223]
    v_mfma_f32_16x16x32_bf16 v[244:247], v[32:35], v[176:179], v[244:247]
    buffer_load_dwordx4 v[4:7], v252, s[36:39], s78 offen offset:0 sc1
    s_waitcnt vmcnt(8)
    v_mfma_f32_16x16x32_bf16 v[188:191], v[16:19], v[144:147], v[188:191]
    v_mfma_f32_16x16x32_bf16 v[200:203], v[20:23], v[144:147], v[200:203]
    v_mfma_f32_16x16x32_bf16 v[212:215], v[24:27], v[144:147], v[212:215]
    v_mfma_f32_16x16x32_bf16 v[224:227], v[28:31], v[144:147], v[224:227]
    v_mfma_f32_16x16x32_bf16 v[248:251], v[32:35], v[144:147], v[248:251]
    s_add_u32 s44, s76, s81
    s_add_u32 s44, s44, 24576
    buffer_load_dwordx4 v[8:11], v252, s[36:39], s44 offen sc1
    buffer_load_dwordx4 v[12:15], v252, s[36:39], s79 offen offset:0 sc1
    s_waitcnt vmcnt(9)
    v_mfma_f32_16x16x32_bf16 v[180:183], v[36:39], v[148:151], v[180:183]
    v_mfma_f32_16x16x32_bf16 v[192:195], v[40:43], v[148:151], v[192:195]
    v_mfma_f32_16x16x32_bf16 v[204:207], v[44:47], v[148:151], v[204:207]
    v_mfma_f32_16x16x32_bf16 v[216:219], v[48:51], v[148:151], v[216:219]
    v_mfma_f32_16x16x32_bf16 v[228:231], v[68:71], v[148:151], v[228:231]
    buffer_load_dwordx4 v[172:175], v252, s[36:39], s80 offen offset:0 sc1
    s_waitcnt vmcnt(9)
    v_mfma_f32_16x16x32_bf16 v[184:187], v[36:39], v[152:155], v[184:187]
    v_mfma_f32_16x16x32_bf16 v[196:199], v[40:43], v[152:155], v[196:199]
    v_mfma_f32_16x16x32_bf16 v[208:211], v[44:47], v[152:155], v[208:211]
    v_mfma_f32_16x16x32_bf16 v[220:223], v[48:51], v[152:155], v[220:223]
    v_mfma_f32_16x16x32_bf16 v[232:235], v[68:71], v[152:155], v[232:235]
    buffer_load_dwordx4 v[176:179], v252, s[36:39], s78 offen offset:1024 sc1
    s_cmp_eq_u32 s67, 4
    s_cselect_b32 s65, 0xfffe4000, s48
    s_add_u32 s78, s78, s65
    s_waitcnt vmcnt(9)
    v_mfma_f32_16x16x32_bf16 v[188:191], v[36:39], v[156:159], v[188:191]
    v_mfma_f32_16x16x32_bf16 v[200:203], v[40:43], v[156:159], v[200:203]
    v_mfma_f32_16x16x32_bf16 v[212:215], v[44:47], v[156:159], v[212:215]
    v_mfma_f32_16x16x32_bf16 v[224:227], v[48:51], v[156:159], v[224:227]
    v_mfma_f32_16x16x32_bf16 v[236:239], v[68:71], v[156:159], v[236:239]
    s_add_u32 s44, s76, s81
    s_add_u32 s44, s44, 32768
    buffer_load_dwordx4 v[144:147], v252, s[36:39], s44 offen sc1
    buffer_load_dwordx4 v[16:19], v252, s[36:39], s79 offen offset:1024 sc1
    s_add_u32 s79, s79, s65
    s_waitcnt vmcnt(10)
    v_mfma_f32_16x16x32_bf16 v[180:183], v[52:55], v[160:163], v[180:183]
    v_mfma_f32_16x16x32_bf16 v[192:195], v[56:59], v[160:163], v[192:195]
    v_mfma_f32_16x16x32_bf16 v[204:207], v[60:63], v[160:163], v[204:207]
    v_mfma_f32_16x16x32_bf16 v[216:219], v[64:67], v[160:163], v[216:219]
    v_mfma_f32_16x16x32_bf16 v[240:243], v[68:71], v[160:163], v[240:243]
    buffer_load_dwordx4 v[20:23], v252, s[36:39], s80 offen offset:1024 sc1
    s_add_u32 s80, s80, s65
    s_waitcnt vmcnt(9)
    v_mfma_f32_16x16x32_bf16 v[184:187], v[52:55], v[168:171], v[184:187]
    v_mfma_f32_16x16x32_bf16 v[196:199], v[56:59], v[168:171], v[196:199]
    v_mfma_f32_16x16x32_bf16 v[208:211], v[60:63], v[168:171], v[208:211]
    v_mfma_f32_16x16x32_bf16 v[220:223], v[64:67], v[168:171], v[220:223]
    v_mfma_f32_16x16x32_bf16 v[244:247], v[68:71], v[168:171], v[244:247]
    buffer_load_dwordx4 v[24:27], v252, s[36:39], s78 offen offset:0 sc1
    s_waitcnt vmcnt(9)
    v_mfma_f32_16x16x32_bf16 v[188:191], v[52:55], v[0:3], v[188:191]
    v_mfma_f32_16x16x32_bf16 v[200:203], v[56:59], v[0:3], v[200:203]
    v_mfma_f32_16x16x32_bf16 v[212:215], v[60:63], v[0:3], v[212:215]
    v_mfma_f32_16x16x32_bf16 v[224:227], v[64:67], v[0:3], v[224:227]
    v_mfma_f32_16x16x32_bf16 v[248:251], v[68:71], v[0:3], v[248:251]
    s_add_u32 s44, s76, s81
    s_add_u32 s44, s44, 40960
    buffer_load_dwordx4 v[28:31], v252, s[36:39], s44 offen sc1
    buffer_load_dwordx4 v[32:35], v252, s[36:39], s79 offen offset:0 sc1
    s_waitcnt vmcnt(10)
    v_mfma_f32_16x16x32_bf16 v[180:183], v[72:75], v[4:7], v[180:183]
    v_mfma_f32_16x16x32_bf16 v[192:195], v[76:79], v[4:7], v[192:195]
    v_mfma_f32_16x16x32_bf16 v[204:207], v[80:83], v[4:7], v[204:207]
    v_mfma_f32_16x16x32_bf16 v[216:219], v[84:87], v[4:7], v[216:219]
    v_mfma_f32_16x16x32_bf16 v[228:231], v[104:107], v[4:7], v[228:231]
    buffer_load_dwordx4 v[148:151], v252, s[36:39], s80 offen offset:0 sc1
    s_waitcnt vmcnt(9)
    v_mfma_f32_16x16x32_bf16 v[184:187], v[72:75], v[12:15], v[184:187]
    v_mfma_f32_16x16x32_bf16 v[196:199], v[76:79], v[12:15], v[196:199]
    v_mfma_f32_16x16x32_bf16 v[208:211], v[80:83], v[12:15], v[208:211]
    v_mfma_f32_16x16x32_bf16 v[220:223], v[84:87], v[12:15], v[220:223]
    v_mfma_f32_16x16x32_bf16 v[232:235], v[104:107], v[12:15], v[232:235]
    buffer_load_dwordx4 v[152:155], v252, s[36:39], s78 offen offset:1024 sc1
    s_cmp_eq_u32 s67, 3
    s_cselect_b32 s65, 0xfffe4000, s48
    s_add_u32 s78, s78, s65
    s_waitcnt vmcnt(9)
    v_mfma_f32_16x16x32_bf16 v[188:191], v[72:75], v[172:175], v[188:191]
    v_mfma_f32_16x16x32_bf16 v[200:203], v[76:79], v[172:175], v[200:203]
    v_mfma_f32_16x16x32_bf16 v[212:215], v[80:83], v[172:175], v[212:215]
    v_mfma_f32_16x16x32_bf16 v[224:227], v[84:87], v[172:175], v[224:227]
    v_mfma_f32_16x16x32_bf16 v[236:239], v[104:107], v[172:175], v[236:239]
    s_add_u32 s44, s76, s81
    s_add_u32 s44, s44, 49152
    buffer_load_dwordx4 v[156:159], v252, s[36:39], s44 offen sc1
    buffer_load_dwordx4 v[36:39], v252, s[36:39], s79 offen offset:1024 sc1
    s_add_u32 s79, s79, s65
    s_waitcnt vmcnt(10)
    v_mfma_f32_16x16x32_bf16 v[180:183], v[88:91], v[176:179], v[180:183]
    v_mfma_f32_16x16x32_bf16 v[192:195], v[92:95], v[176:179], v[192:195]
    v_mfma_f32_16x16x32_bf16 v[204:207], v[96:99], v[176:179], v[204:207]
    v_mfma_f32_16x16x32_bf16 v[216:219], v[100:103], v[176:179], v[216:219]
    v_mfma_f32_16x16x32_bf16 v[240:243], v[104:107], v[176:179], v[240:243]
    buffer_load_dwordx4 v[40:43], v252, s[36:39], s80 offen offset:1024 sc1
    s_add_u32 s80, s80, s65
    s_waitcnt vmcnt(9)
    v_mfma_f32_16x16x32_bf16 v[184:187], v[88:91], v[16:19], v[184:187]
    v_mfma_f32_16x16x32_bf16 v[196:199], v[92:95], v[16:19], v[196:199]
    v_mfma_f32_16x16x32_bf16 v[208:211], v[96:99], v[16:19], v[208:211]
    v_mfma_f32_16x16x32_bf16 v[220:223], v[100:103], v[16:19], v[220:223]
    v_mfma_f32_16x16x32_bf16 v[244:247], v[104:107], v[16:19], v[244:247]
    buffer_load_dwordx4 v[44:47], v252, s[36:39], s78 offen offset:0 sc1
    s_waitcnt vmcnt(9)
    v_mfma_f32_16x16x32_bf16 v[188:191], v[88:91], v[20:23], v[188:191]
    v_mfma_f32_16x16x32_bf16 v[200:203], v[92:95], v[20:23], v[200:203]
    v_mfma_f32_16x16x32_bf16 v[212:215], v[96:99], v[20:23], v[212:215]
    v_mfma_f32_16x16x32_bf16 v[224:227], v[100:103], v[20:23], v[224:227]
    v_mfma_f32_16x16x32_bf16 v[248:251], v[104:107], v[20:23], v[248:251]
    s_add_u32 s44, s76, s81
    s_add_u32 s44, s44, 57344
    buffer_load_dwordx4 v[48:51], v252, s[36:39], s44 offen sc1
    buffer_load_dwordx4 v[160:163], v252, s[36:39], s79 offen offset:0 sc1
    s_waitcnt vmcnt(10)
    v_mfma_f32_16x16x32_bf16 v[180:183], v[108:111], v[24:27], v[180:183]
    v_mfma_f32_16x16x32_bf16 v[192:195], v[112:115], v[24:27], v[192:195]
    v_mfma_f32_16x16x32_bf16 v[204:207], v[116:119], v[24:27], v[204:207]
    v_mfma_f32_16x16x32_bf16 v[216:219], v[120:123], v[24:27], v[216:219]
    v_mfma_f32_16x16x32_bf16 v[228:231], v[140:143], v[24:27], v[228:231]
    buffer_load_dwordx4 v[168:171], v252, s[36:39], s80 offen offset:0 sc1
    s_waitcnt vmcnt(9)
    v_mfma_f32_16x16x32_bf16 v[184:187], v[108:111], v[32:35], v[184:187]
    v_mfma_f32_16x16x32_bf16 v[196:199], v[112:115], v[32:35], v[196:199]
    v_mfma_f32_16x16x32_bf16 v[208:211], v[116:119], v[32:35], v[208:211]
    v_mfma_f32_16x16x32_bf16 v[220:223], v[120:123], v[32:35], v[220:223]
    v_mfma_f32_16x16x32_bf16 v[232:235], v[140:143], v[32:35], v[232:235]
    buffer_load_dwordx4 v[0:3], v252, s[36:39], s78 offen offset:1024 sc1
    s_cmp_eq_u32 s67, 2
    s_cselect_b32 s65, 0xfffe4000, s48
    s_add_u32 s78, s78, s65
    s_waitcnt vmcnt(9)
    v_mfma_f32_16x16x32_bf16 v[188:191], v[108:111], v[148:151], v[188:191]
    v_mfma_f32_16x16x32_bf16 v[200:203], v[112:115], v[148:151], v[200:203]
    v_mfma_f32_16x16x32_bf16 v[212:215], v[116:119], v[148:151], v[212:215]
    v_mfma_f32_16x16x32_bf16 v[224:227], v[120:123], v[148:151], v[224:227]
    v_mfma_f32_16x16x32_bf16 v[236:239], v[140:143], v[148:151], v[236:239]
    s_add_u32 s44, s76, s81
    s_add_u32 s44, s44, 65536
    buffer_load_dwordx4 v[52:55], v252, s[36:39], s44 offen sc1
    ds_read_b128 v[56:59], v254 offset:32768
    ds_read_b128 v[60:63], v254 offset:40960
    ds_read_b128 v[64:67], v254 offset:49152
    ds_read_b128 v[68:71], v254 offset:57344
    ds_read_b128 v[4:7], v253 offset:0
    buffer_load_dwordx4 v[12:15], v252, s[36:39], s79 offen offset:1024 sc1
    s_add_u32 s79, s79, s65
    s_waitcnt vmcnt(10)
    v_mfma_f32_16x16x32_bf16 v[180:183], v[124:127], v[152:155], v[180:183]
    v_mfma_f32_16x16x32_bf16 v[192:195], v[128:131], v[152:155], v[192:195]
    v_mfma_f32_16x16x32_bf16 v[204:207], v[132:135], v[152:155], v[204:207]
    v_mfma_f32_16x16x32_bf16 v[216:219], v[136:139], v[152:155], v[216:219]
    v_mfma_f32_16x16x32_bf16 v[240:243], v[140:143], v[152:155], v[240:243]
    buffer_load_dwordx4 v[172:175], v252, s[36:39], s80 offen offset:1024 sc1
    s_add_u32 s80, s80, s65
    s_waitcnt vmcnt(9)
    v_mfma_f32_16x16x32_bf16 v[184:187], v[124:127], v[36:39], v[184:187]
    v_mfma_f32_16x16x32_bf16 v[196:199], v[128:131], v[36:39], v[196:199]
    v_mfma_f32_16x16x32_bf16 v[208:211], v[132:135], v[36:39], v[208:211]
    v_mfma_f32_16x16x32_bf16 v[220:223], v[136:139], v[36:39], v[220:223]
    v_mfma_f32_16x16x32_bf16 v[244:247], v[140:143], v[36:39], v[244:247]
    buffer_load_dwordx4 v[72:75], v252, s[36:39], s78 offen offset:0 sc1
    s_waitcnt vmcnt(9)
    v_mfma_f32_16x16x32_bf16 v[188:191], v[124:127], v[40:43], v[188:191]
    v_mfma_f32_16x16x32_bf16 v[200:203], v[128:131], v[40:43], v[200:203]
    v_mfma_f32_16x16x32_bf16 v[212:215], v[132:135], v[40:43], v[212:215]
    v_mfma_f32_16x16x32_bf16 v[224:227], v[136:139], v[40:43], v[224:227]
    v_mfma_f32_16x16x32_bf16 v[248:251], v[140:143], v[40:43], v[248:251]
    ds_read_b128 v[76:79], v255 offset:0
    ds_read_b128 v[80:83], v255 offset:8192
    ds_read_b128 v[84:87], v255 offset:16384
    ds_read_b128 v[176:179], v255 offset:24576
    buffer_load_dwordx4 v[16:19], v252, s[36:39], s79 offen offset:0 sc1
    s_waitcnt vmcnt(9)
    s_waitcnt lgkmcnt(4)
    v_mfma_f32_16x16x32_bf16 v[180:183], v[56:59], v[44:47], v[180:183]
    v_mfma_f32_16x16x32_bf16 v[192:195], v[60:63], v[44:47], v[192:195]
    v_mfma_f32_16x16x32_bf16 v[204:207], v[64:67], v[44:47], v[204:207]
    v_mfma_f32_16x16x32_bf16 v[216:219], v[68:71], v[44:47], v[216:219]
    v_mfma_f32_16x16x32_bf16 v[228:231], v[4:7], v[44:47], v[228:231]
    buffer_load_dwordx4 v[20:23], v252, s[36:39], s80 offen offset:0 sc1
    s_waitcnt vmcnt(8)
    v_mfma_f32_16x16x32_bf16 v[184:187], v[56:59], v[160:163], v[184:187]
    v_mfma_f32_16x16x32_bf16 v[196:199], v[60:63], v[160:163], v[196:199]
    v_mfma_f32_16x16x32_bf16 v[208:211], v[64:67], v[160:163], v[208:211]
    v_mfma_f32_16x16x32_bf16 v[220:223], v[68:71], v[160:163], v[220:223]
    v_mfma_f32_16x16x32_bf16 v[232:235], v[4:7], v[160:163], v[232:235]
    buffer_load_dwordx4 v[88:91], v252, s[36:39], s78 offen offset:1024 sc1
    s_cmp_eq_u32 s67, 1
    s_cselect_b32 s65, 0xfffe4000, s48
    s_add_u32 s78, s78, s65
    s_waitcnt vmcnt(8)
    v_mfma_f32_16x16x32_bf16 v[188:191], v[56:59], v[168:171], v[188:191]
    v_mfma_f32_16x16x32_bf16 v[200:203], v[60:63], v[168:171], v[200:203]
    v_mfma_f32_16x16x32_bf16 v[212:215], v[64:67], v[168:171], v[212:215]
    v_mfma_f32_16x16x32_bf16 v[224:227], v[68:71], v[168:171], v[224:227]
    v_mfma_f32_16x16x32_bf16 v[236:239], v[4:7], v[168:171], v[236:239]
    ds_read_b128 v[92:95], v253 offset:8192
    ds_read_b128 v[96:99], v254 offset:16384
    ds_read_b128 v[100:103], v254 offset:24576
    ds_read_b128 v[104:107], v253 offset:16384
    ds_read_b128 v[24:27], v253 offset:57344
    buffer_load_dwordx4 v[32:35], v252, s[36:39], s79 offen offset:1024 sc1
    s_add_u32 s79, s79, s65
    s_waitcnt vmcnt(8)
    s_waitcnt lgkmcnt(5)
    v_mfma_f32_16x16x32_bf16 v[180:183], v[76:79], v[0:3], v[180:183]
    v_mfma_f32_16x16x32_bf16 v[192:195], v[80:83], v[0:3], v[192:195]
    v_mfma_f32_16x16x32_bf16 v[204:207], v[84:87], v[0:3], v[204:207]
    v_mfma_f32_16x16x32_bf16 v[216:219], v[176:179], v[0:3], v[216:219]
    v_mfma_f32_16x16x32_bf16 v[240:243], v[4:7], v[0:3], v[240:243]
    buffer_load_dwordx4 v[148:151], v252, s[36:39], s80 offen offset:1024 sc1
    s_add_u32 s80, s80, s65
    s_waitcnt vmcnt(7)
    v_mfma_f32_16x16x32_bf16 v[184:187], v[76:79], v[12:15], v[184:187]
    v_mfma_f32_16x16x32_bf16 v[196:199], v[80:83], v[12:15], v[196:199]
    v_mfma_f32_16x16x32_bf16 v[208:211], v[84:87], v[12:15], v[208:211]
    v_mfma_f32_16x16x32_bf16 v[220:223], v[176:179], v[12:15], v[220:223]
    v_mfma_f32_16x16x32_bf16 v[244:247], v[4:7], v[12:15], v[244:247]
    buffer_load_dwordx4 v[108:111], v252, s[36:39], s78 offen offset:0 sc1
    s_waitcnt vmcnt(7)
    v_mfma_f32_16x16x32_bf16 v[188:191], v[76:79], v[172:175], v[188:191]
    v_mfma_f32_16x16x32_bf16 v[200:203], v[80:83], v[172:175], v[200:203]
    v_mfma_f32_16x16x32_bf16 v[212:215], v[84:87], v[172:175], v[212:215]
    v_mfma_f32_16x16x32_bf16 v[224:227], v[176:179], v[172:175], v[224:227]
    v_mfma_f32_16x16x32_bf16 v[248:251], v[4:7], v[172:175], v[248:251]
    ds_read_b128 v[112:115], v253 offset:24576
    ds_read_b128 v[116:119], v253 offset:32768
    ds_read_b128 v[120:123], v253 offset:40960
    ds_read_b128 v[152:155], v253 offset:49152
    buffer_load_dwordx4 v[36:39], v252, s[36:39], s79 offen offset:0 sc1
    s_waitcnt vmcnt(7)
    s_waitcnt lgkmcnt(4)
    v_mfma_f32_16x16x32_bf16 v[180:183], v[92:95], v[72:75], v[180:183]
    v_mfma_f32_16x16x32_bf16 v[192:195], v[96:99], v[72:75], v[192:195]
    v_mfma_f32_16x16x32_bf16 v[204:207], v[100:103], v[72:75], v[204:207]
    v_mfma_f32_16x16x32_bf16 v[216:219], v[104:107], v[72:75], v[216:219]
    v_mfma_f32_16x16x32_bf16 v[228:231], v[24:27], v[72:75], v[228:231]
    buffer_load_dwordx4 v[40:43], v252, s[36:39], s80 offen offset:0 sc1
    s_waitcnt vmcnt(7)
    v_mfma_f32_16x16x32_bf16 v[184:187], v[92:95], v[16:19], v[184:187]
    v_mfma_f32_16x16x32_bf16 v[196:199], v[96:99], v[16:19], v[196:199]
    v_mfma_f32_16x16x32_bf16 v[208:211], v[100:103], v[16:19], v[208:211]
    v_mfma_f32_16x16x32_bf16 v[220:223], v[104:107], v[16:19], v[220:223]
    v_mfma_f32_16x16x32_bf16 v[232:235], v[24:27], v[16:19], v[232:235]
    buffer_load_dwordx4 v[124:127], v252, s[36:39], s78 offen offset:1024 sc1
    s_waitcnt vmcnt(7)
    v_mfma_f32_16x16x32_bf16 v[188:191], v[92:95], v[20:23], v[188:191]
    v_mfma_f32_16x16x32_bf16 v[200:203], v[96:99], v[20:23], v[200:203]
    v_mfma_f32_16x16x32_bf16 v[212:215], v[100:103], v[20:23], v[212:215]
    v_mfma_f32_16x16x32_bf16 v[224:227], v[104:107], v[20:23], v[224:227]
    v_mfma_f32_16x16x32_bf16 v[236:239], v[24:27], v[20:23], v[236:239]
    ds_read_b128 v[128:131], v254 offset:0
    ds_read_b128 v[132:135], v254 offset:8192
    buffer_load_dwordx4 v[136:139], v252, s[36:39], s79 offen offset:1024 sc1
    s_waitcnt vmcnt(7)
    s_waitcnt lgkmcnt(2)
    v_mfma_f32_16x16x32_bf16 v[180:183], v[112:115], v[88:91], v[180:183]
    v_mfma_f32_16x16x32_bf16 v[192:195], v[116:119], v[88:91], v[192:195]
    v_mfma_f32_16x16x32_bf16 v[204:207], v[120:123], v[88:91], v[204:207]
    v_mfma_f32_16x16x32_bf16 v[216:219], v[152:155], v[88:91], v[216:219]
    v_mfma_f32_16x16x32_bf16 v[240:243], v[24:27], v[88:91], v[240:243]
    buffer_load_dwordx4 v[140:143], v252, s[36:39], s80 offen offset:1024 sc1
    s_waitcnt vmcnt(7)
    v_mfma_f32_16x16x32_bf16 v[184:187], v[112:115], v[32:35], v[184:187]
    v_mfma_f32_16x16x32_bf16 v[196:199], v[116:119], v[32:35], v[196:199]
    v_mfma_f32_16x16x32_bf16 v[208:211], v[120:123], v[32:35], v[208:211]
    v_mfma_f32_16x16x32_bf16 v[220:223], v[152:155], v[32:35], v[220:223]
    v_mfma_f32_16x16x32_bf16 v[244:247], v[24:27], v[32:35], v[244:247]
    s_waitcnt vmcnt(6)
    v_mfma_f32_16x16x32_bf16 v[188:191], v[112:115], v[148:151], v[188:191]
    v_mfma_f32_16x16x32_bf16 v[200:203], v[116:119], v[148:151], v[200:203]
    v_mfma_f32_16x16x32_bf16 v[212:215], v[120:123], v[148:151], v[212:215]
    v_mfma_f32_16x16x32_bf16 v[224:227], v[152:155], v[148:151], v[224:227]
    v_mfma_f32_16x16x32_bf16 v[248:251], v[24:27], v[148:151], v[248:251]
    s_waitcnt vmcnt(5)
    s_waitcnt lgkmcnt(0)
    v_mfma_f32_16x16x32_bf16 v[180:183], v[128:131], v[108:111], v[180:183]
    v_mfma_f32_16x16x32_bf16 v[192:195], v[132:135], v[108:111], v[192:195]
    v_mfma_f32_16x16x32_bf16 v[204:207], v[164:167], v[108:111], v[204:207]
    v_mfma_f32_16x16x32_bf16 v[216:219], v[8:11], v[108:111], v[216:219]
    v_mfma_f32_16x16x32_bf16 v[228:231], v[52:55], v[108:111], v[228:231]
    s_waitcnt vmcnt(4)
    v_mfma_f32_16x16x32_bf16 v[184:187], v[128:131], v[36:39], v[184:187]
    v_mfma_f32_16x16x32_bf16 v[196:199], v[132:135], v[36:39], v[196:199]
    v_mfma_f32_16x16x32_bf16 v[208:211], v[164:167], v[36:39], v[208:211]
    v_mfma_f32_16x16x32_bf16 v[220:223], v[8:11], v[36:39], v[220:223]
    v_mfma_f32_16x16x32_bf16 v[232:235], v[52:55], v[36:39], v[232:235]
    s_waitcnt vmcnt(3)
    v_mfma_f32_16x16x32_bf16 v[188:191], v[128:131], v[40:43], v[188:191]
    v_mfma_f32_16x16x32_bf16 v[200:203], v[132:135], v[40:43], v[200:203]
    v_mfma_f32_16x16x32_bf16 v[212:215], v[164:167], v[40:43], v[212:215]
    v_mfma_f32_16x16x32_bf16 v[224:227], v[8:11], v[40:43], v[224:227]
    v_mfma_f32_16x16x32_bf16 v[236:239], v[52:55], v[40:43], v[236:239]
    s_waitcnt vmcnt(2)
    v_mfma_f32_16x16x32_bf16 v[180:183], v[144:147], v[124:127], v[180:183]
    v_mfma_f32_16x16x32_bf16 v[192:195], v[28:31], v[124:127], v[192:195]
    v_mfma_f32_16x16x32_bf16 v[204:207], v[156:159], v[124:127], v[204:207]
    v_mfma_f32_16x16x32_bf16 v[216:219], v[48:51], v[124:127], v[216:219]
    v_mfma_f32_16x16x32_bf16 v[240:243], v[52:55], v[124:127], v[240:243]
    s_waitcnt vmcnt(1)
    v_mfma_f32_16x16x32_bf16 v[184:187], v[144:147], v[136:139], v[184:187]
    v_mfma_f32_16x16x32_bf16 v[196:199], v[28:31], v[136:139], v[196:199]
    v_mfma_f32_16x16x32_bf16 v[208:211], v[156:159], v[136:139], v[208:211]
    v_mfma_f32_16x16x32_bf16 v[220:223], v[48:51], v[136:139], v[220:223]
    v_mfma_f32_16x16x32_bf16 v[244:247], v[52:55], v[136:139], v[244:247]
    s_waitcnt vmcnt(0)
    v_mfma_f32_16x16x32_bf16 v[188:191], v[144:147], v[140:143], v[188:191]
    v_mfma_f32_16x16x32_bf16 v[200:203], v[28:31], v[140:143], v[200:203]
    v_mfma_f32_16x16x32_bf16 v[212:215], v[156:159], v[140:143], v[212:215]
    v_mfma_f32_16x16x32_bf16 v[224:227], v[48:51], v[140:143], v[224:227]
    v_mfma_f32_16x16x32_bf16 v[248:251], v[52:55], v[140:143], v[248:251]
    ds_write_b128 v253, v[180:183] offset:0
    ds_write_b128 v253, v[192:195] offset:24576
    ds_write_b128 v253, v[204:207] offset:49152
    ds_write_b128 v254, v[216:219] offset:8192
    ds_write_b128 v253, v[184:187] offset:8192
    ds_write_b128 v253, v[196:199] offset:32768
    ds_write_b128 v253, v[208:211] offset:57344
    ds_write_b128 v254, v[220:223] offset:16384
    ds_write_b128 v253, v[188:191] offset:16384
    ds_write_b128 v253, v[200:203] offset:40960
    ds_write_b128 v254, v[212:215] offset:0
    ds_write_b128 v254, v[224:227] offset:24576
    s_mov_b32 exec_hi, 0
    ds_write_b128 v254, v[228:231] offset:32768
    ds_write_b128 v254, v[232:235] offset:40960
    ds_write_b128 v254, v[236:239] offset:49152
    s_not_b64 exec, exec
    ds_write_b128 v254, v[240:243] offset:32768
    ds_write_b128 v254, v[244:247] offset:40960
    ds_write_b128 v254, v[248:251] offset:49152
    s_mov_b64 exec, -1
    s_lshl_b32 s44, s40, 13
    v_add_u32 v2, s44, v252
    v_add_u32 v3, 65536, v2
    s_mul_i32 s75, s75, 144
    s_add_u32 s44, s40, 0
    s_mul_i32 s45, s44, 86
    s_lshr_b32 s45, s45, 8
    s_sub_u32 s65, s74, s45
    s_mul_i32 s65, s65, 3
    s_add_u32 s44, s44, s65
    s_mul_i32 s44, s44, 18432
    s_lshl_b32 s45, s45, 5
    s_add_u32 s44, s44, s45
    s_add_u32 s53, s44, s75
    s_add_u32 s44, s40, 8
    s_mul_i32 s45, s44, 86
    s_lshr_b32 s45, s45, 8
    s_sub_u32 s65, s74, s45
    s_mul_i32 s65, s65, 3
    s_add_u32 s44, s44, s65
    s_mul_i32 s44, s44, 18432
    s_lshl_b32 s45, s45, 5
    s_add_u32 s44, s44, s45
    s_add_u32 s54, s44, s75
    v_bfe_u32 v4, v252, 4, 4
    v_mul_u32_u24 v4, 1152, v4
    v_lshrrev_b32 v5, 8, v252
    v_lshl_add_u32 v4, v5, 3, v4
    s_waitcnt lgkmcnt(0)
    s_barrier
    ds_read_b128 v[8:11], v2 offset:0
    ds_read_b128 v[12:15], v2 offset:1024
    ds_read_b128 v[16:19], v2 offset:2048
    ds_read_b128 v[20:23], v2 offset:3072
    ds_read_b128 v[24:27], v2 offset:4096
    ds_read_b128 v[28:31], v2 offset:5120
    ds_read_b128 v[32:35], v2 offset:6144
    ds_read_b128 v[36:39], v2 offset:7168
    ds_read_b128 v[40:43], v3 offset:0
    ds_read_b128 v[44:47], v3 offset:1024
    ds_read_b128 v[48:51], v3 offset:2048
    ds_read_b128 v[52:55], v3 offset:3072
    ds_read_b128 v[56:59], v3 offset:4096
    ds_read_b128 v[60:63], v3 offset:5120
    ds_read_b128 v[64:67], v3 offset:6144
    ds_read_b128 v[68:71], v3 offset:7168
    s_waitcnt lgkmcnt(8)
    v_pk_add_f32 v[8:9], v[8:9], v[24:25]
    v_pk_add_f32 v[10:11], v[10:11], v[26:27]
    v_pk_add_f32 v[12:13], v[12:13], v[28:29]
    v_pk_add_f32 v[14:15], v[14:15], v[30:31]
    v_pk_add_f32 v[16:17], v[16:17], v[32:33]
    v_pk_add_f32 v[18:19], v[18:19], v[34:35]
    v_pk_add_f32 v[20:21], v[20:21], v[36:37]
    v_pk_add_f32 v[22:23], v[22:23], v[38:39]
    v_pk_add_f32 v[8:9], v[8:9], v[16:17]
    v_pk_add_f32 v[10:11], v[10:11], v[18:19]
    v_pk_add_f32 v[12:13], v[12:13], v[20:21]
    v_pk_add_f32 v[14:15], v[14:15], v[22:23]
    v_pk_add_f32 v[8:9], v[8:9], v[12:13]
    v_pk_add_f32 v[10:11], v[10:11], v[14:15]
    v_cvt_pk_bf16_f32 v8, v8, v9
    v_cvt_pk_bf16_f32 v9, v10, v11
    buffer_store_dwordx2 v[8:9], v4, s[32:35], s53 offen
    s_waitcnt lgkmcnt(0)
    v_pk_add_f32 v[40:41], v[40:41], v[56:57]
    v_pk_add_f32 v[42:43], v[42:43], v[58:59]
    v_pk_add_f32 v[44:45], v[44:45], v[60:61]
    v_pk_add_f32 v[46:47], v[46:47], v[62:63]
    v_pk_add_f32 v[48:49], v[48:49], v[64:65]
    v_pk_add_f32 v[50:51], v[50:51], v[66:67]
    v_pk_add_f32 v[52:53], v[52:53], v[68:69]
    v_pk_add_f32 v[54:55], v[54:55], v[70:71]
    v_pk_add_f32 v[40:41], v[40:41], v[48:49]
    v_pk_add_f32 v[42:43], v[42:43], v[50:51]
    v_pk_add_f32 v[44:45], v[44:45], v[52:53]
    v_pk_add_f32 v[46:47], v[46:47], v[54:55]
    v_pk_add_f32 v[40:41], v[40:41], v[44:45]
    v_pk_add_f32 v[42:43], v[42:43], v[46:47]
    s_cmp_lt_u32 s40, 4
    s_cbranch_scc1 L_full
    s_cmp_eq_u32 s40, 7
    s_cbranch_scc1 L_fin
    v_mov_b32 v44, v40
    v_mov_b32 v45, v41
    v_mov_b32 v46, v42
    v_mov_b32 v47, v43
    s_nop 1
    v_permlane32_swap_b32 v40, v44
    v_permlane32_swap_b32 v41, v45
    v_permlane32_swap_b32 v42, v46
    v_permlane32_swap_b32 v43, v47
    s_nop 0
    v_add_f32 v40, v40, v44
    v_add_f32 v41, v41, v45
    v_add_f32 v42, v42, v46
    v_add_f32 v43, v43, v47
    s_mov_b32 exec_hi, 0
L_full:
    v_cvt_pk_bf16_f32 v40, v40, v41
    v_cvt_pk_bf16_f32 v41, v42, v43
    buffer_store_dwordx2 v[40:41], v4, s[32:35], s54 offen
L_fin:
    s_endpgm
L_redo:
    s_mov_b32 s62, 1
    s_lshl_b32 s44, s41, 5
    s_add_u32 s44, s44, s42
    s_lshl_b32 s44, s44, 17
    s_add_u32 s24, s6, s44
    s_addc_u32 s25, s7, 0
    s_mov_b32 s26, 131072
    s_mov_b32 s27, 0x00020000
    s_waitcnt vmcnt(0)
    s_barrier
    v_lshrrev_b32 v235, 4, v235
    v_and_b32 v231, 15, v235
    v_lshlrev_b32 v231, 8, v231
    v_lshrrev_b32 v232, 4, v235
    v_lshl_add_u32 v231, v232, 4, v231
    v_mov_b32 v228, 0xff800000
    v_mov_b32 v229, 0xff800000
    v_mov_b32 v230, 0xff800000
    v_pk_mov_b32 v[0:1], 0, 0
    v_pk_mov_b32 v[2:3], 0, 0
    v_pk_mov_b32 v[4:5], 0, 0
    v_pk_mov_b32 v[6:7], 0, 0
    v_pk_mov_b32 v[8:9], 0, 0
    v_pk_mov_b32 v[10:11], 0, 0
    v_pk_mov_b32 v[12:13], 0, 0
    v_pk_mov_b32 v[14:15], 0, 0
    v_pk_mov_b32 v[16:17], 0, 0
    v_pk_mov_b32 v[18:19], 0, 0
    v_pk_mov_b32 v[20:21], 0, 0
    v_pk_mov_b32 v[22:23], 0, 0
    v_pk_mov_b32 v[24:25], 0, 0
    v_pk_mov_b32 v[26:27], 0, 0
    v_pk_mov_b32 v[28:29], 0, 0
    v_pk_mov_b32 v[30:31], 0, 0
    v_pk_mov_b32 v[32:33], 0, 0
    v_pk_mov_b32 v[34:35], 0, 0
    v_pk_mov_b32 v[36:37], 0, 0
    v_pk_mov_b32 v[38:39], 0, 0
    v_pk_mov_b32 v[40:41], 0, 0
    v_pk_mov_b32 v[42:43], 0, 0
    v_pk_mov_b32 v[44:45], 0, 0
    v_pk_mov_b32 v[46:47], 0, 0
    v_pk_mov_b32 v[48:49], 0, 0
    v_pk_mov_b32 v[50:51], 0, 0
    v_pk_mov_b32 v[52:53], 0, 0
    v_pk_mov_b32 v[54:55], 0, 0
    v_pk_mov_b32 v[56:57], 0, 0
    v_pk_mov_b32 v[58:59], 0, 0
    v_pk_mov_b32 v[60:61], 0, 0
    v_pk_mov_b32 v[62:63], 0, 0
    v_pk_mov_b32 v[64:65], 0, 0
    v_pk_mov_b32 v[66:67], 0, 0
    v_pk_mov_b32 v[68:69], 0, 0
    v_pk_mov_b32 v[70:71], 0, 0
    v_pk_mov_b32 v[72:73], 0, 0
    v_pk_mov_b32 v[74:75], 0, 0
    v_pk_mov_b32 v[76:77], 0, 0
    v_pk_mov_b32 v[78:79], 0, 0
    v_pk_mov_b32 v[80:81], 0, 0
    v_pk_mov_b32 v[82:83], 0, 0
    v_pk_mov_b32 v[84:85], 0, 0
    v_pk_mov_b32 v[86:87], 0, 0
    v_pk_mov_b32 v[88:89], 0, 0
    v_pk_mov_b32 v[90:91], 0, 0
    v_pk_mov_b32 v[92:93], 0, 0
    v_pk_mov_b32 v[94:95], 0, 0
    s_mov_b32 s65, 0
L_redo_max:
    buffer_load_dwordx4 v[192:195], v231, s[24:27], s65 offen offset:0
    buffer_load_dwordx4 v[196:199], v231, s[24:27], s65 offen offset:64
    buffer_load_dwordx4 v[200:203], v231, s[24:27], s65 offen offset:128
    buffer_load_dwordx4 v[204:207], v231, s[24:27], s65 offen offset:192
    s_waitcnt vmcnt(0)
    v_mfma_f32_16x16x32_bf16 v[100:103], v[192:195], v[96:99], 0
    v_mfma_f32_16x16x32_bf16 v[108:111], v[192:195], v[104:107], 0
    v_mfma_f32_16x16x32_bf16 v[116:119], v[192:195], v[112:115], 0
    v_mfma_f32_16x16x32_bf16 v[100:103], v[196:199], v[120:123], v[100:103]
    v_mfma_f32_16x16x32_bf16 v[108:111], v[196:199], v[128:131], v[108:111]
    v_mfma_f32_16x16x32_bf16 v[116:119], v[196:199], v[136:139], v[116:119]
    v_mfma_f32_16x16x32_bf16 v[100:103], v[200:203], v[144:147], v[100:103]
    v_mfma_f32_16x16x32_bf16 v[108:111], v[200:203], v[152:155], v[108:111]
    v_mfma_f32_16x16x32_bf16 v[116:119], v[200:203], v[160:163], v[116:119]
    v_mfma_f32_16x16x32_bf16 v[100:103], v[204:207], v[168:171], v[100:103]
    v_mfma_f32_16x16x32_bf16 v[108:111], v[204:207], v[176:179], v[108:111]
    v_mfma_f32_16x16x32_bf16 v[116:119], v[204:207], v[184:187], v[116:119]
    s_nop 7
    s_nop 7
    v_max3_f32 v228, v228, v100, v101
    v_max3_f32 v229, v229, v108, v109
    v_max3_f32 v230, v230, v116, v117
    v_max3_f32 v228, v228, v102, v103
    v_max3_f32 v229, v229, v110, v111
    v_max3_f32 v230, v230, v118, v119
    s_add_u32 s65, s65, 4096
    s_cmp_lt_u32 s65, 131072
    s_cbranch_scc1 L_redo_max
    v_xor_b32 v224, 180224, v224
    v_xor_b32 v225, 180224, v225
    v_xor_b32 v226, 180224, v226
    v_xor_b32 v227, 180224, v227
    v_xor_b32 v248, 212992, v248
    v_xor_b32 v249, 212992, v249
    v_xor_b32 v250, 212992, v250
    v_xor_b32 v251, 212992, v251
    v_xor_b32 v252, 212992, v252
    v_xor_b32 v253, 212992, v253
    v_xor_b32 v254, 212992, v254
    v_xor_b32 v255, 212992, v255
    s_barrier
    ds_read_b128 v[192:195], v224 offset:0
    ds_read_b128 v[196:199], v225 offset:0
    ds_read_b128 v[200:203], v226 offset:0
    ds_read_b128 v[204:207], v227 offset:0
    ds_read_b128 v[208:211], v224 offset:1024
    ds_read_b128 v[212:215], v225 offset:1024
    ds_read_b128 v[216:219], v226 offset:1024
    ds_read_b128 v[220:223], v227 offset:1024
    s_waitcnt lgkmcnt(0)
    v_mfma_f32_16x16x32_bf16 v[100:103], v[192:195], v[96:99], 0
    v_mfma_f32_16x16x32_bf16 v[108:111], v[192:195], v[104:107], 0
    v_mfma_f32_16x16x32_bf16 v[116:119], v[192:195], v[112:115], 0
    v_mfma_f32_16x16x32_bf16 v[100:103], v[196:199], v[120:123], v[100:103]
    v_mfma_f32_16x16x32_bf16 v[108:111], v[196:199], v[128:131], v[108:111]
    v_mfma_f32_16x16x32_bf16 v[116:119], v[196:199], v[136:139], v[116:119]
    v_mfma_f32_16x16x32_bf16 v[100:103], v[200:203], v[144:147], v[100:103]
    v_mfma_f32_16x16x32_bf16 v[108:111], v[200:203], v[152:155], v[108:111]
    v_mfma_f32_16x16x32_bf16 v[116:119], v[200:203], v[160:163], v[116:119]
    v_mfma_f32_16x16x32_bf16 v[100:103], v[204:207], v[168:171], v[100:103]
    v_mfma_f32_16x16x32_bf16 v[108:111], v[204:207], v[176:179], v[108:111]
    v_mfma_f32_16x16x32_bf16 v[116:119], v[204:207], v[184:187], v[116:119]
    s_branch L_reenter
L_endA:
    s_endpgm
.section .rodata,"a"
.p2align 6
.amdhsa_kernel standalone__mha_block_cached__near_ridge_kernel
  .amdhsa_next_free_vgpr 256
  .amdhsa_next_free_sgpr 102
  .amdhsa_accum_offset 256
  .amdhsa_group_segment_fixed_size 0
  .amdhsa_kernarg_size 64
  .amdhsa_user_sgpr_count 2
  .amdhsa_user_sgpr_kernarg_segment_ptr 1
  .amdhsa_system_sgpr_workgroup_id_x 1
.end_amdhsa_kernel
```
